```python
import torch

def _softmax(x, axis=-1):
    return torch.softmax(x, dim=axis)
def _gelu(x):
    return torch.nn.functional.gelu(x, approximate="tanh")
def _silu(x):
    return torch.nn.functional.silu(x)
def _sigmoid(x):
    return torch.sigmoid(x)
def _layernorm(x, axis=-1, eps=1e-5):
    m = x.mean(dim=axis, keepdim=True)
    v = x.var(dim=axis, keepdim=True, unbiased=False)
    return (x - m) / torch.sqrt(v + eps)
def _scatter_add(tgt, idx, src, axis=0):
    return tgt.clone().index_add_(axis, idx, src)
def _segment_sum(src, seg, n):
    out = torch.zeros((n,) + src.shape[1:], dtype=src.dtype)
    return out.index_add_(0, seg, src)
def _pad(x, pw):
    flat = tuple(v for pair in reversed(pw) for v in pair)
    return torch.nn.functional.pad(x, flat)

kernel_name = 'recurrent_scan__ssm_conv_s4d__moe_arch_mod__prompt'

def setup_inputs():

    _w = (lambda a: (lambda t: t.to(torch.bfloat16) if t.is_floating_point() else t)(torch.as_tensor(a)))
    def _A_setup():
        Bsz, L, D, N = 1, 2048, 512, 128
        return {
            "u": _w((lambda *s: torch.randn(*s, dtype=torch.bfloat16) * 0.05)(Bsz, L, D)),
            "log_A_real": _w((lambda *s: torch.randn(*s, dtype=torch.bfloat16) * 3.2)(D, N) * 0.5),
            "A_imag": _w((lambda *s: torch.randn(*s, dtype=torch.bfloat16) * 0.05)(D, N) * 3.14),
            "C_real": _w((lambda *s: torch.randn(*s, dtype=torch.bfloat16) * 0.1)(D, N) / N ** 0.5),
            "C_imag": _w((lambda *s: torch.randn(*s, dtype=torch.bfloat16) * 0.1)(D, N) / N ** 0.5),
            "log_dt": _w((lambda *s: torch.randn(*s, dtype=torch.bfloat16) * 0.05)(D) * 0.5 - 4.0),
            "D_skip": _w((lambda *s: torch.randn(*s, dtype=torch.bfloat16) * 0.05)(D)),
        }
    _A_in = _A_setup()

    def _B_setup():
        B, S, D, F, C = 1, 2048, 512, 1376, 2
        return {
            "x": _w((lambda *s: torch.randn(*s, dtype=torch.bfloat16) * 0.05)(B, S, D)),
            "w_r": _w((lambda *s: torch.randn(*s, dtype=torch.bfloat16) * 3.2)(D)),
            "w_gate": _w((lambda *s: torch.randn(*s, dtype=torch.bfloat16) * 0.1)(D, F)),
            "w_up": _w((lambda *s: torch.randn(*s, dtype=torch.bfloat16) * 0.1)(D, F)),
            "w_down": _w((lambda *s: torch.randn(*s, dtype=torch.bfloat16) * 0.1)(F, D)),
        }
    _B_in = _B_setup()

    return {
        "A_u": _A_in["u"],
        "A_log_A_real": _A_in["log_A_real"],
        "A_A_imag": _A_in["A_imag"],
        "A_C_real": _A_in["C_real"],
        "A_C_imag": _A_in["C_imag"],
        "A_log_dt": _A_in["log_dt"],
        "A_D_skip": _A_in["D_skip"],
        "B_x": _B_in["x"],
        "B_w_r": _B_in["w_r"],
        "B_w_gate": _B_in["w_gate"],
        "B_w_up": _B_in["w_up"],
        "B_w_down": _B_in["w_down"],
    }

def reference(A_u, A_log_A_real, A_A_imag, A_C_real, A_C_imag, A_log_dt, A_D_skip, B_x, B_w_r, B_w_gate, B_w_up, B_w_down):
    def _A_ref(u, log_A_real, A_imag, C_real, C_imag, log_dt, D_skip):
        L = u.shape[1]
        dt = torch.exp(log_dt)
        A = -torch.exp(log_A_real) + 1j * A_imag
        C = (C_real + 1j * C_imag) * dt[:, None]
        pos = (lambda x, dt: x.to(dt))(torch.arange(L), log_dt.dtype)
        P = torch.exp((A * dt[:, None])[:, :, None] * pos[None, None, :])
        K = 2.0 * torch.einsum("dn,dnl->dl", C, P).real
        L2 = 2 * L
        u_t = (lambda x, *d: x.permute(*d))(u, 0, 2, 1)
        Kf = (lambda x, *a, **k: torch.fft.rfft(x.float(), *a, **k))(K, L2)
        Uf = (lambda x, *a, **k: torch.fft.rfft(x.float(), *a, **k))(u_t, L2)
        y = (lambda x, *a, **k: torch.fft.irfft(x, *a, **k).to(torch.bfloat16))(Uf * Kf[None, :, :], L2)[:, :, :L]
        y = (lambda x, *d: x.permute(*d))(y, 0, 2, 1)
        return y + u * D_skip[None, None, :]

    def _B_ref(x, w_r, w_gate, w_up, w_down):
        B, S, D = x.shape
        C = 2
        r = x @ w_r
        idx = torch.argsort(-r, axis=-1)[:, :C]
        idx_e = (lambda x, n, axis: torch.repeat_interleave(x, n, dim=axis))(idx.reshape(B, C, 1), D, axis=2)
        x_sel = (lambda x, i, axis: torch.take_along_dim(x, i, dim=axis))(x, idx_e, axis=1)
        g = _silu(x_sel @ w_gate)
        u = x_sel @ w_up
        y = (g * u) @ w_down
        r_sel = _sigmoid((lambda x, i, axis: torch.take_along_dim(x, i, dim=axis))(r, idx, axis=1))
        y = y * r_sel.reshape(B, C, 1)
        b_off = (torch.arange(B) * S).reshape(B, 1)
        flat_idx = (idx + b_off).reshape(B * C)
        zero = (x * 0.0).reshape(B * S, D)
        upd = _scatter_add(zero, flat_idx, y.reshape(B * C, D), axis=0)
        return x + upd.reshape(B, S, D)

    x = A_u
    xn = _layernorm(x, axis=-1)
    s = _A_ref(xn, A_log_A_real, A_A_imag, A_C_real, A_C_imag, A_log_dt, A_D_skip)
    g = _silu(_B_ref(xn, B_w_r, B_w_gate, B_w_up, B_w_down))
    return x + s * g
```

```asm
; @launch grid=(256,1,1) block=(512,1,1) lds=131392
.amdgcn_target "amdgcn-amd-amdhsa--gfx950"
.text
.globl recurrent_scan__ssm_conv_s4d__moe_arch_mod__prompt_kernel
.p2align 8
.type recurrent_scan__ssm_conv_s4d__moe_arch_mod__prompt_kernel,@function
recurrent_scan__ssm_conv_s4d__moe_arch_mod__prompt_kernel:
    s_getpc_b64 s[12:13]
L_pc:
    s_load_dwordx16 s[16:31], s[0:1], 0
    s_load_dwordx8 s[32:39], s[0:1], 64
    s_bfe_u32 s11, s2, 0x20003
    v_lshl_add_u32 v2, v0, 2, s11
    v_lshlrev_b32 v2, 7, v2
    v_min_u32 v2, L_codeend-L_pc-4, v2
    global_load_dword v238, v2, s[12:13]
L_nocpf:
    v_lshrrev_b32 v5, 6, v0
    v_and_b32 v13, 31, v0
    v_readfirstlane_b32 s47, v5
    v_lshlrev_b32 v13, 4, v13
    v_lshrrev_b32 v15, 5, v0
    s_lshl_b32 s11, s2, 13
    v_lshl_add_u32 v15, v15, 10, v13
    s_lshr_b32 s4, s2, 8
    s_cbranch_scc1 L_end
    v_add_u32 v15, s11, v15
    s_cmp_lt_u32 s47, 4
    s_waitcnt lgkmcnt(0)
    s_cbranch_scc0 L_norows
    global_load_dwordx4 v[16:19], v15, s[16:17]
    global_load_dwordx4 v[20:23], v15, s[16:17] offset:512
    global_load_dwordx4 v[24:27], v13, s[32:33]
    global_load_dwordx4 v[28:31], v13, s[32:33] offset:512
    s_setprio 3
L_norows:
    s_load_dwordx2 s[44:45], s[0:1], 112
    s_and_b32 s4, s2, 7
    s_lshr_b32 s5, s2, 3
    s_lshl_b32 s6, s4, 5
    s_add_u32 s6, s6, s5
    s_lshl_b32 s11, s6, 9
    v_and_b32 v14, 127, v0
    v_lshl_add_u32 v14, v14, 2, s11
    s_lshl_b32 s59, s6, 2
    v_and_b32 v1, 63, v0
    s_mov_b32 s58, s2
    global_load_dword v4, v14, s[18:19]
    global_load_dword v5, v14, s[20:21]
    global_load_dword v6, v14, s[22:23]
    global_load_dword v7, v14, s[24:25]
    s_waitcnt lgkmcnt(0)
    s_load_dword s10, s[44:45], 0
    s_load_dword s8, s[26:27], s59
    s_load_dword s9, s[28:29], s59
    s_load_dwordx4 s[40:43], s[0:1], 96
    v_xor_b32 v0, 0x100, v0
    s_xor_b32 s3, s47, 4
    s_and_b32 s14, s3, 1
    s_lshr_b32 s15, s3, 1
    v_lshlrev_b32 v9, 4, v1
    v_add_u32 v9, L_ctab-L_pc, v9
    s_mov_b32 s56, 0xffff0000
    s_mov_b32 s57, 0xffff
    s_mul_i32 s60, s4, 11
    s_add_u32 s60, s60, s5
    s_sub_u32 s60, s60, 21
    s_cmp_ge_u32 s5, 21
    s_cselect_b32 s61, 1, 0
    s_cmp_lt_u32 s60, 86
    s_cselect_b32 s61, s61, 0
    s_and_b32 s89, s5, 15
    s_mul_i32 s11, s14, 33760
    v_lshl_add_u32 v48, v1, 3, s11
    s_mov_b32 s101, 0x3e22f983
    s_mov_b32 s63, 0x43800000
    s_cmp_lt_u32 s3, 4
    s_cbranch_scc1 L_conv_head
    s_lshl_b32 s58, s58, 3
    s_lshl_b32 s11, s47, 1
    s_add_u32 s58, s58, s11
    global_load_dwordx4 v[188:191], v9, s[12:13]
    s_and_b32 s82, s5, 15
    s_lshl_b32 s82, s82, 7
    s_lshl_b32 s11, s47, 5
    s_add_u32 s82, s82, s11
    v_and_b32 v231, 7, v1
    v_lshrrev_b32 v233, 3, v1
    v_add_u32 v196, s82, v233
    s_lshl_b32 s11, s4, 7
    v_lshl_add_u32 v192, v231, 4, s11
    v_lshl_add_u32 v192, v196, 10, v192
    v_add_u32 v193, 8192, v192
    v_add_u32 v194, 16384, v192
    v_add_u32 v195, 24576, v192
    v_lshl_add_u32 v232, v231, 2, s82
    s_getreg_b32 s99, hwreg(HW_REG_XCC_ID, 0, 4)
    s_and_b32 s11, s58, 0xffffff00
    s_lshl_b32 s11, s11, 3
    s_bfe_u32 s82, s58, 0x10001
    s_lshl_b32 s82, s82, 10
    s_add_u32 s11, s11, s82
    s_bfe_u32 s82, s58, 0x60002
    s_lshl_b32 s82, s82, 4
    s_add_u32 s11, s11, s82
    s_add_u32 s11, s11, 4096
    v_mov_b32 v12, s11
    s_mov_b32 s62, 4.0
    s_mov_b32 s98, 0
    s_mov_b32 s100, 0xbfb8aa3b
    s_lshl_b32 s58, s47, 11
    s_add_u32 s58, s58, 4096
    v_lshl_add_u32 v2, v1, 4, s58
    v_add_u32 v3, 8192, v2
    s_lshl_b32 s58, s4, 8
    s_lshl_b32 s59, s47, 5
    s_add_u32 s83, s58, 32768
    s_add_u32 s58, s83, s59
    v_lshl_add_u32 v112, v233, 2, s58
    s_lshl_b32 s58, s6, 13
    s_lshl_b32 s11, s47, 10
    s_add_u32 s58, s58, s11
    s_add_u32 s58, s58, 1050624
    v_lshl_add_u32 v113, v1, 4, s58
    s_lshl_b32 s11, s4, 18
    s_add_u32 s11, s11, 1048576
    v_lshl_add_u32 v172, v233, 15, s11
    v_lshl_add_u32 v172, v232, 2, v172
    v_add_u32 v173, 8192, v172
    s_mul_i32 s58, s47, 4608
    s_add_u32 s58, s58, 98624
    v_mul_u32_u24 v197, 144, v233
    v_lshl_add_u32 v197, v231, 4, v197
    v_add_u32 v197, s58, v197
    v_mul_u32_u24 v198, 144, v231
    v_lshl_add_u32 v198, v233, 2, v198
    v_add_u32 v198, s58, v198
    v_mov_b32 v117, 0
    v_add_u32 v174, 16384, v172
    v_add_u32 v175, 24576, v172
    s_lshl_b32 s58, s89, 4
    s_add_u32 s58, s58, s83
    s_lshl_b32 s11, s47, 2
    s_add_u32 s58, s58, s11
    v_mov_b32 v126, s58
    s_mul_i32 s71, s14, 33760
    s_mul_i32 s70, s14, 9280
    s_lshl_b32 s59, s15, 7
    s_add_u32 s70, s70, s59
    s_add_u32 s70, s70, 67272
    s_lshl_b32 s76, s15, 4
    s_and_b32 s76, s76, 16
    v_mov_b32 v182, 96132
    v_mov_b32 v183, 1
    s_mov_b32 s58, 0x3f803f80
    s_cmp_lt_u32 s5, 16
    s_waitcnt vmcnt(7)
    s_cbranch_scc0 L_lw0
    global_load_dwordx4 v[136:139], v192, s[16:17]
    global_load_dwordx4 v[140:143], v193, s[16:17]
    global_load_dwordx4 v[144:147], v194, s[16:17]
    global_load_dwordx4 v[148:151], v195, s[16:17]
L_lw0:
    v_dot2_f32_bf16 v64, v16, s58, 0
    v_dot2_f32_bf16 v56, v16, v16, 0
    v_dot2_f32_bf16 v64, v17, s58, v64
    v_dot2_f32_bf16 v56, v17, v17, v56
    v_dot2_f32_bf16 v64, v18, s58, v64
    v_dot2_f32_bf16 v56, v18, v18, v56
    v_dot2_f32_bf16 v64, v19, s58, v64
    v_dot2_f32_bf16 v56, v19, v19, v56
    v_dot2_f32_bf16 v64, v20, s58, v64
    v_dot2_f32_bf16 v56, v20, v20, v56
    v_dot2_f32_bf16 v64, v21, s58, v64
    v_dot2_f32_bf16 v56, v21, v21, v56
    v_dot2_f32_bf16 v64, v22, s58, v64
    v_dot2_f32_bf16 v56, v22, v22, v56
    v_dot2_f32_bf16 v64, v23, s58, v64
    v_dot2_f32_bf16 v56, v23, v23, v56
    s_cbranch_scc1 L_lw1
    s_waitcnt vmcnt(5)
L_lw1:
    s_waitcnt vmcnt(9)
    v_dot2_f32_bf16 v68, v16, v24, 0
    v_dot2_f32_bf16 v66, v24, s58, 0
    v_dot2_f32_bf16 v68, v17, v25, v68
    v_dot2_f32_bf16 v66, v25, s58, v66
    v_dot2_f32_bf16 v68, v18, v26, v68
    v_dot2_f32_bf16 v66, v26, s58, v66
    v_dot2_f32_bf16 v68, v19, v27, v68
    v_dot2_f32_bf16 v66, v27, s58, v66
    v_dot2_f32_bf16 v68, v20, v28, v68
    v_dot2_f32_bf16 v66, v28, s58, v66
    v_dot2_f32_bf16 v68, v21, v29, v68
    v_dot2_f32_bf16 v66, v29, s58, v66
    v_dot2_f32_bf16 v68, v22, v30, v68
    v_dot2_f32_bf16 v66, v30, s58, v66
    v_dot2_f32_bf16 v68, v23, v31, v68
    v_dot2_f32_bf16 v66, v31, s58, v66
    s_waitcnt lgkmcnt(0)
    s_add_u32 s7, s10, 0x9e3779b0
    s_andn2_b32 s7, s7, 15
    s_or_b32 s46, s7, s99
    v_add_f32_dpp v64, v64, v64 row_ror:8 row_mask:0xf bank_mask:0xf
    v_add_f32_dpp v56, v56, v56 row_ror:8 row_mask:0xf bank_mask:0xf
    v_add_f32_dpp v68, v68, v68 row_ror:8 row_mask:0xf bank_mask:0xf
    v_add_f32_dpp v66, v66, v66 row_ror:8 row_mask:0xf bank_mask:0xf
    v_add_f32_dpp v64, v64, v64 row_ror:4 row_mask:0xf bank_mask:0xf
    v_add_f32_dpp v56, v56, v56 row_ror:4 row_mask:0xf bank_mask:0xf
    v_add_f32_dpp v68, v68, v68 row_ror:4 row_mask:0xf bank_mask:0xf
    v_add_f32_dpp v66, v66, v66 row_ror:4 row_mask:0xf bank_mask:0xf
    v_add_f32_dpp v64, v64, v64 row_ror:2 row_mask:0xf bank_mask:0xf
    v_add_f32_dpp v56, v56, v56 row_ror:2 row_mask:0xf bank_mask:0xf
    v_add_f32_dpp v68, v68, v68 row_ror:2 row_mask:0xf bank_mask:0xf
    v_add_f32_dpp v66, v66, v66 row_ror:2 row_mask:0xf bank_mask:0xf
    v_add_f32_dpp v64, v64, v64 row_ror:1 row_mask:0xf bank_mask:0xf
    v_add_f32_dpp v56, v56, v56 row_ror:1 row_mask:0xf bank_mask:0xf
    v_add_f32_dpp v68, v68, v68 row_ror:1 row_mask:0xf bank_mask:0xf
    v_add_f32_dpp v66, v66, v66 row_ror:1 row_mask:0xf bank_mask:0xf
    v_mov_b32 v65, v64
    v_mov_b32 v57, v56
    v_mov_b32 v69, v68
    v_mov_b32 v67, v66
    v_mov_b32 v11, s46
    v_permlane16_swap_b32 v64, v65
    v_permlane16_swap_b32 v56, v57
    v_permlane16_swap_b32 v68, v69
    v_permlane16_swap_b32 v66, v67
    v_add_f32 v64, v64, v65
    v_add_f32 v56, v56, v57
    v_add_f32 v68, v68, v69
    v_add_f32 v66, v66, v67
    v_mul_f32 v50, 0x3b000000, v64
    v_mul_f32 v56, 0x3b000000, v56
    v_cvt_pk_bf16_f32 v54, v50, v50
    v_mul_f32 v51, v50, v50
    v_sub_f32 v56, v56, v51
    v_and_b32 v52, s56, v54
    v_mul_f32 v57, 0x42800000, v56
    v_fma_f32 v68, -v52, v66, v68
    v_cmp_gt_f32 vcc, v51, v57
    v_cvt_pk_bf16_f32 v56, v56, v56
    s_cbranch_vccnz L_lnslow
L_lnjoin:
    v_and_b32 v56, s56, v56
    v_add_f32 v56, 0x3727c5ac, v56
    v_cvt_pk_bf16_f32 v56, v56, v56
    v_and_b32 v56, s56, v56
    v_sqrt_f32 v56, v56
    s_nop 0
    v_cvt_pk_bf16_f32 v56, v56, v56
    v_and_b32 v56, s56, v56
    v_rcp_f32 v57, v56
    v_and_or_b32 v8, v54, s57, v56
    v_mul_f32 v68, v68, v57
    v_cvt_pk_bf16_f32 v68, v68, v68
    v_readlane_b32 s58, v8, 32
    v_ashrrev_i32 v69, 31, v68
    v_or_b32 v69, 0x80000000, v69
    v_xor_b32 v68, v68, v69
    v_lshrrev_b32 v68, 16, v68
    v_mov_b32 v9, s58
    v_readlane_b32 s59, v68, 32
    s_nop 0
    s_lshl_b32 s59, s59, 16
    v_or_b32 v10, s59, v68
    s_mov_b64 exec, 1
    global_store_dwordx4 v12, v[8:11], s[44:45] sc1
    s_mov_b64 exec, -1
    s_setprio 0
    v_mov_b32 v125, s46
    v_mov_b32 v69, 96560
    ds_write_b32 v69, v125
    s_mov_b32 s48, s40
    s_and_b32 s49, s41, 0xffff
    s_mov_b32 s50, 0x200000
    s_mov_b32 s51, 0x20000
    s_lshl_b32 s11, s14, 4
    s_lshr_b32 s58, s8, s11
    s_lshl_b32 s58, s58, 16
    v_mov_b32 v61, 0x3fb8aa3b
    v_mul_f32 v60, s58, v61
    v_exp_f32 v60, v60
    s_nop 0
    v_cvt_pk_bf16_f32 v60, v60, v60
    v_and_b32 v60, s56, v60
    v_mul_f32 v57, 0xbfb8aa3b, v60
    v_mul_f32 v59, s101, v60
    v_mul_f32 v56, s62, v57
    v_mul_f32 v57, s63, v57
    v_mul_f32 v58, s62, v59
    v_mul_f32 v59, s63, v59
    v_add_f32 v60, v60, v60
    s_cmp_lt_u32 s5, 16
    s_cbranch_scc1 L_hw5
    s_waitcnt vmcnt(1)
L_hw5:
    s_waitcnt vmcnt(5)
    v_lshlrev_b32 v8, 16, v4
    v_and_b32 v9, s56, v4
    v_mul_f32 v8, v8, v61
    v_mul_f32 v9, v9, v61
    v_lshlrev_b32 v10, 16, v5
    v_and_b32 v11, s56, v5
    v_exp_f32 v8, v8
    v_exp_f32 v9, v9
    v_mul_f32 v30, v10, v58
    v_mul_f32 v31, v11, v58
    v_mul_f32 v38, v10, v59
    v_mul_f32 v39, v11, v59
    v_cvt_pk_bf16_f32 v9, v8, v9
    v_fract_f32 v30, v30
    v_fract_f32 v31, v31
    v_lshlrev_b32 v8, 16, v9
    v_and_b32 v9, s56, v9
    v_fract_f32 v38, v38
    v_fract_f32 v39, v39
    v_mul_f32 v28, v8, v56
    v_mul_f32 v29, v9, v56
    v_mul_f32 v36, v8, v57
    v_mul_f32 v37, v9, v57
    v_cos_f32 v16, v30
    v_sin_f32 v17, v30
    v_cos_f32 v18, v31
    v_sin_f32 v19, v31
    v_exp_f32 v28, v28
    v_exp_f32 v29, v29
    v_cos_f32 v20, v38
    v_sin_f32 v21, v38
    v_cos_f32 v22, v39
    v_sin_f32 v23, v39
    v_exp_f32 v36, v36
    v_exp_f32 v37, v37
    v_pk_mul_f32 v[16:17], v[16:17], v[28:29] op_sel_hi:[1,0]
    v_pk_mul_f32 v[18:19], v[18:19], v[28:29] op_sel:[0,1] op_sel_hi:[1,1]
    v_pk_mul_f32 v[20:21], v[20:21], v[36:37] op_sel_hi:[1,0]
    v_pk_mul_f32 v[22:23], v[22:23], v[36:37] op_sel:[0,1] op_sel_hi:[1,1]
    s_cmp_lt_u32 s5, 16
    s_cbranch_scc0 L_hc
    s_waitcnt vmcnt(1)
    ds_write_b32 v198, v136 offset:0
    ds_write_b32 v198, v137 offset:1152
    ds_write_b32 v198, v138 offset:2304
    ds_write_b32 v198, v139 offset:3456
    ds_write_b32 v198, v140 offset:32
    ds_write_b32 v198, v141 offset:1184
    ds_write_b32 v198, v142 offset:2336
    ds_write_b32 v198, v143 offset:3488
    ds_write_b32 v198, v144 offset:64
    ds_write_b32 v198, v145 offset:1216
    ds_write_b32 v198, v146 offset:2368
    ds_write_b32 v198, v147 offset:3520
    ds_write_b32 v198, v148 offset:96
    ds_write_b32 v198, v149 offset:1248
    ds_write_b32 v198, v150 offset:2400
    ds_write_b32 v198, v151 offset:3552
    ds_read_b128 v[152:155], v197 offset:0
    ds_read_b128 v[156:159], v197 offset:1152
    ds_read_b128 v[160:163], v197 offset:2304
    ds_read_b128 v[164:167], v197 offset:3456
L_hc:
    v_lshlrev_b32 v12, 16, v6
    v_lshlrev_b32 v13, 16, v7
    v_and_b32 v14, s56, v6
    v_and_b32 v15, s56, v7
    v_pk_mul_f32 v[12:13], v[12:13], v[60:61] op_sel_hi:[1,0]
    v_pk_mul_f32 v[14:15], v[14:15], v[60:61] op_sel_hi:[1,0]
    v_pk_mul_f32 v[40:41], v[16:17], v[16:17] op_sel:[0,0] op_sel_hi:[1,0]
    v_pk_mul_f32 v[42:43], v[18:19], v[18:19] op_sel:[0,0] op_sel_hi:[1,0]
    v_pk_fma_f32 v[24:25], v[16:17], v[16:17], v[40:41] op_sel:[1,1,0] op_sel_hi:[0,1,1] neg_lo:[1,0,0]
    v_pk_fma_f32 v[26:27], v[18:19], v[18:19], v[42:43] op_sel:[1,1,0] op_sel_hi:[0,1,1] neg_lo:[1,0,0]
    s_cmp_lt_u32 s5, 16
    s_cbranch_scc0 L_hprep
    s_waitcnt lgkmcnt(3)
    global_store_dwordx4 v172, v[152:155], s[44:45]
    s_waitcnt lgkmcnt(2)
    global_store_dwordx4 v173, v[156:159], s[44:45]
    s_waitcnt lgkmcnt(1)
    global_store_dwordx4 v174, v[160:163], s[44:45]
    s_waitcnt lgkmcnt(0)
    global_store_dwordx4 v175, v[164:167], s[44:45]
L_hprep:
    s_cmp_eq_u32 s15, 3
    s_cbranch_scc1 L_roleR2
    v_pk_mul_f32 v[52:53], v[12:13], v[16:17] op_sel:[0,0] op_sel_hi:[1,0]
    v_pk_mul_f32 v[54:55], v[14:15], v[18:19] op_sel:[0,0] op_sel_hi:[1,0]
    v_pk_fma_f32 v[28:29], v[12:13], v[16:17], v[52:53] op_sel:[1,1,0] op_sel_hi:[0,1,1] neg_lo:[1,0,0]
    v_pk_fma_f32 v[30:31], v[14:15], v[18:19], v[54:55] op_sel:[1,1,0] op_sel_hi:[0,1,1] neg_lo:[1,0,0]
    v_pk_mul_f32 v[40:41], v[24:25], v[24:25] op_sel:[0,0] op_sel_hi:[1,0]
    v_pk_mul_f32 v[42:43], v[26:27], v[26:27] op_sel:[0,0] op_sel_hi:[1,0]
    v_pk_fma_f32 v[24:25], v[24:25], v[24:25], v[40:41] op_sel:[1,1,0] op_sel_hi:[0,1,1] neg_lo:[1,0,0]
    v_pk_fma_f32 v[26:27], v[26:27], v[26:27], v[42:43] op_sel:[1,1,0] op_sel_hi:[0,1,1] neg_lo:[1,0,0]
    v_pk_mul_f32 v[52:53], v[12:13], v[20:21] op_sel:[0,0] op_sel_hi:[1,0]
    v_pk_mul_f32 v[54:55], v[14:15], v[22:23] op_sel:[0,0] op_sel_hi:[1,0]
    v_pk_fma_f32 v[12:13], v[12:13], v[20:21], v[52:53] op_sel:[1,1,0] op_sel_hi:[0,1,1] neg_lo:[1,0,0]
    v_pk_fma_f32 v[14:15], v[14:15], v[22:23], v[54:55] op_sel:[1,1,0] op_sel_hi:[0,1,1] neg_lo:[1,0,0]
    v_cvt_pk_bf16_f32 v44, v28, v29
    v_cvt_pk_bf16_f32 v45, v30, v31
    ds_write_b64 v48, v[44:45] offset:10336
    v_pk_mul_f32 v[40:41], v[12:13], v[24:25] op_sel:[0,0] op_sel_hi:[1,0]
    v_pk_mul_f32 v[42:43], v[14:15], v[26:27] op_sel:[0,0] op_sel_hi:[1,0]
    v_pk_fma_f32 v[36:37], v[12:13], v[24:25], v[40:41] op_sel:[1,1,0] op_sel_hi:[0,1,1] neg_lo:[1,0,0]
    v_pk_fma_f32 v[38:39], v[14:15], v[26:27], v[42:43] op_sel:[1,1,0] op_sel_hi:[0,1,1] neg_lo:[1,0,0]
    v_pk_mul_f32 v[52:53], v[28:29], v[20:21] op_sel:[0,0] op_sel_hi:[1,0]
    v_pk_mul_f32 v[54:55], v[30:31], v[22:23] op_sel:[0,0] op_sel_hi:[1,0]
    v_pk_fma_f32 v[28:29], v[28:29], v[20:21], v[52:53] op_sel:[1,1,0] op_sel_hi:[0,1,1] neg_lo:[1,0,0]
    v_pk_fma_f32 v[30:31], v[30:31], v[22:23], v[54:55] op_sel:[1,1,0] op_sel_hi:[0,1,1] neg_lo:[1,0,0]
    v_cvt_pk_bf16_f32 v46, v12, v13
    v_cvt_pk_bf16_f32 v47, v14, v15
    ds_write_b64 v48, v[46:47] offset:20128
    v_cvt_pk_bf16_f32 v44, v36, v37
    v_cvt_pk_bf16_f32 v45, v38, v39
    ds_write_b64 v48, v[44:45] offset:23936
    v_pk_mul_f32 v[40:41], v[36:37], v[20:21] op_sel:[0,0] op_sel_hi:[1,0]
    v_pk_mul_f32 v[42:43], v[38:39], v[22:23] op_sel:[0,0] op_sel_hi:[1,0]
    v_pk_fma_f32 v[36:37], v[36:37], v[20:21], v[40:41] op_sel:[1,1,0] op_sel_hi:[0,1,1] neg_lo:[1,0,0]
    v_pk_fma_f32 v[38:39], v[38:39], v[22:23], v[42:43] op_sel:[1,1,0] op_sel_hi:[0,1,1] neg_lo:[1,0,0]
    v_cvt_pk_bf16_f32 v46, v28, v29
    v_cvt_pk_bf16_f32 v47, v30, v31
    ds_write_b64 v48, v[46:47] offset:18496
    v_pk_mul_f32 v[52:53], v[12:13], v[20:21] op_sel:[0,0] op_sel_hi:[1,0]
    v_pk_mul_f32 v[54:55], v[14:15], v[22:23] op_sel:[0,0] op_sel_hi:[1,0]
    v_pk_fma_f32 v[12:13], v[12:13], v[20:21], v[52:53] op_sel:[1,1,0] op_sel_hi:[0,1,1] neg_lo:[1,0,0]
    v_pk_fma_f32 v[14:15], v[14:15], v[22:23], v[54:55] op_sel:[1,1,0] op_sel_hi:[0,1,1] neg_lo:[1,0,0]
    s_cmp_lt_u32 s5, 16
    s_cbranch_scc1 L_pm3
    s_lshl_b32 s11, s89, 5
    s_lshr_b32 s59, s47, 1
    s_lshl_b32 s59, s59, 4
    s_add_u32 s11, s11, s59
    v_lshrrev_b32 v127, 2, v1
    v_add_u32 v127, s11, v127
    v_mul_u32_u24 v127, 2752, v127
    v_and_b32 v124, 3, v1
    v_lshlrev_b32 v124, 7, v124
    v_min_u32 v124, 348, v124
    s_mul_i32 s11, s4, 352
    v_add3_u32 v127, v127, v124, s11
    v_min_u32 v127, 1409020, v127
    s_cmp_eq_u32 s14, 0
    s_cselect_b32 s80, s34, s36
    s_cselect_b32 s81, s35, s37
    global_load_dword v238, v127, s[80:81]
L_pm3:
    v_pk_mul_f32 v[52:53], v[28:29], v[20:21] op_sel:[0,0] op_sel_hi:[1,0]
    v_pk_mul_f32 v[54:55], v[30:31], v[22:23] op_sel:[0,0] op_sel_hi:[1,0]
    v_pk_fma_f32 v[28:29], v[28:29], v[20:21], v[52:53] op_sel:[1,1,0] op_sel_hi:[0,1,1] neg_lo:[1,0,0]
    v_pk_fma_f32 v[30:31], v[30:31], v[22:23], v[54:55] op_sel:[1,1,0] op_sel_hi:[0,1,1] neg_lo:[1,0,0]
    v_cvt_pk_bf16_f32 v44, v12, v13
    v_cvt_pk_bf16_f32 v45, v14, v15
    ds_write_b64 v48, v[44:45] offset:22304
    v_cvt_pk_bf16_f32 v46, v36, v37
    v_cvt_pk_bf16_f32 v47, v38, v39
    ds_write_b64 v48, v[46:47] offset:23392
    v_pk_mul_f32 v[40:41], v[36:37], v[20:21] op_sel:[0,0] op_sel_hi:[1,0]
    v_pk_mul_f32 v[42:43], v[38:39], v[22:23] op_sel:[0,0] op_sel_hi:[1,0]
    v_pk_fma_f32 v[36:37], v[36:37], v[20:21], v[40:41] op_sel:[1,1,0] op_sel_hi:[0,1,1] neg_lo:[1,0,0]
    v_pk_fma_f32 v[38:39], v[38:39], v[22:23], v[42:43] op_sel:[1,1,0] op_sel_hi:[0,1,1] neg_lo:[1,0,0]
    v_cvt_pk_bf16_f32 v44, v28, v29
    v_cvt_pk_bf16_f32 v45, v30, v31
    ds_write_b64 v48, v[44:45] offset:22848
    v_pk_mul_f32 v[52:53], v[12:13], v[20:21] op_sel:[0,0] op_sel_hi:[1,0]
    v_pk_mul_f32 v[54:55], v[14:15], v[22:23] op_sel:[0,0] op_sel_hi:[1,0]
    v_pk_fma_f32 v[12:13], v[12:13], v[20:21], v[52:53] op_sel:[1,1,0] op_sel_hi:[0,1,1] neg_lo:[1,0,0]
    v_pk_fma_f32 v[14:15], v[14:15], v[22:23], v[54:55] op_sel:[1,1,0] op_sel_hi:[0,1,1] neg_lo:[1,0,0]
    v_pk_mul_f32 v[52:53], v[28:29], v[20:21] op_sel:[0,0] op_sel_hi:[1,0]
    v_pk_mul_f32 v[54:55], v[30:31], v[22:23] op_sel:[0,0] op_sel_hi:[1,0]
    v_pk_fma_f32 v[28:29], v[28:29], v[20:21], v[52:53] op_sel:[1,1,0] op_sel_hi:[0,1,1] neg_lo:[1,0,0]
    v_pk_fma_f32 v[30:31], v[30:31], v[22:23], v[54:55] op_sel:[1,1,0] op_sel_hi:[0,1,1] neg_lo:[1,0,0]
    v_cvt_pk_bf16_f32 v46, v12, v13
    v_cvt_pk_bf16_f32 v47, v14, v15
    ds_write_b64 v48, v[46:47] offset:28832
    v_cvt_pk_bf16_f32 v44, v36, v37
    v_cvt_pk_bf16_f32 v45, v38, v39
    ds_write_b64 v48, v[44:45] offset:21760
    v_pk_mul_f32 v[40:41], v[36:37], v[20:21] op_sel:[0,0] op_sel_hi:[1,0]
    v_pk_mul_f32 v[42:43], v[38:39], v[22:23] op_sel:[0,0] op_sel_hi:[1,0]
    v_pk_fma_f32 v[36:37], v[36:37], v[20:21], v[40:41] op_sel:[1,1,0] op_sel_hi:[0,1,1] neg_lo:[1,0,0]
    v_pk_fma_f32 v[38:39], v[38:39], v[22:23], v[42:43] op_sel:[1,1,0] op_sel_hi:[0,1,1] neg_lo:[1,0,0]
    v_cvt_pk_bf16_f32 v46, v28, v29
    v_cvt_pk_bf16_f32 v47, v30, v31
    ds_write_b64 v48, v[46:47] offset:25568
    v_cvt_pk_bf16_f32 v44, v36, v37
    v_cvt_pk_bf16_f32 v45, v38, v39
    ds_write_b64 v48, v[44:45] offset:27200
    v_pk_mul_f32 v[40:41], v[36:37], v[20:21] op_sel:[0,0] op_sel_hi:[1,0]
    v_pk_mul_f32 v[42:43], v[38:39], v[22:23] op_sel:[0,0] op_sel_hi:[1,0]
    v_pk_fma_f32 v[36:37], v[36:37], v[20:21], v[40:41] op_sel:[1,1,0] op_sel_hi:[0,1,1] neg_lo:[1,0,0]
    v_pk_fma_f32 v[38:39], v[38:39], v[22:23], v[42:43] op_sel:[1,1,0] op_sel_hi:[0,1,1] neg_lo:[1,0,0]
    s_cmp_lt_u32 s5, 16
    s_cbranch_scc0 L_fm3
    s_waitcnt vmcnt(0)
    s_mov_b64 exec, 1
    global_store_dword v126, v125, s[44:45]
    s_mov_b64 exec, -1
L_fm3:
    v_cvt_pk_bf16_f32 v46, v36, v37
    v_cvt_pk_bf16_f32 v47, v38, v39
    ds_write_b64 v48, v[46:47] offset:27744
    v_pk_mul_f32 v[40:41], v[36:37], v[20:21] op_sel:[0,0] op_sel_hi:[1,0]
    v_pk_mul_f32 v[42:43], v[38:39], v[22:23] op_sel:[0,0] op_sel_hi:[1,0]
    v_pk_fma_f32 v[36:37], v[36:37], v[20:21], v[40:41] op_sel:[1,1,0] op_sel_hi:[0,1,1] neg_lo:[1,0,0]
    v_pk_fma_f32 v[38:39], v[38:39], v[22:23], v[42:43] op_sel:[1,1,0] op_sel_hi:[0,1,1] neg_lo:[1,0,0]
    v_cvt_pk_bf16_f32 v44, v36, v37
    v_cvt_pk_bf16_f32 v45, v38, v39
    ds_write_b64 v48, v[44:45] offset:29920
    v_pk_mul_f32 v[40:41], v[36:37], v[20:21] op_sel:[0,0] op_sel_hi:[1,0]
    v_pk_mul_f32 v[42:43], v[38:39], v[22:23] op_sel:[0,0] op_sel_hi:[1,0]
    v_pk_fma_f32 v[36:37], v[36:37], v[20:21], v[40:41] op_sel:[1,1,0] op_sel_hi:[0,1,1] neg_lo:[1,0,0]
    v_pk_fma_f32 v[38:39], v[38:39], v[22:23], v[42:43] op_sel:[1,1,0] op_sel_hi:[0,1,1] neg_lo:[1,0,0]
    v_cvt_pk_bf16_f32 v46, v36, v37
    v_cvt_pk_bf16_f32 v47, v38, v39
    ds_write_b64 v48, v[46:47] offset:32640
    s_branch L_helper
L_roleR2:
    v_pk_mul_f32 v[52:53], v[12:13], v[24:25] op_sel:[0,0] op_sel_hi:[1,0]
    v_pk_mul_f32 v[54:55], v[14:15], v[26:27] op_sel:[0,0] op_sel_hi:[1,0]
    v_pk_fma_f32 v[28:29], v[12:13], v[24:25], v[52:53] op_sel:[1,1,0] op_sel_hi:[0,1,1] neg_lo:[1,0,0]
    v_pk_fma_f32 v[30:31], v[14:15], v[26:27], v[54:55] op_sel:[1,1,0] op_sel_hi:[0,1,1] neg_lo:[1,0,0]
    v_pk_mul_f32 v[40:41], v[28:29], v[16:17] op_sel:[0,0] op_sel_hi:[1,0]
    v_pk_mul_f32 v[42:43], v[30:31], v[18:19] op_sel:[0,0] op_sel_hi:[1,0]
    v_pk_fma_f32 v[32:33], v[28:29], v[16:17], v[40:41] op_sel:[1,1,0] op_sel_hi:[0,1,1] neg_lo:[1,0,0]
    v_pk_fma_f32 v[34:35], v[30:31], v[18:19], v[42:43] op_sel:[1,1,0] op_sel_hi:[0,1,1] neg_lo:[1,0,0]
    v_cvt_pk_bf16_f32 v44, v28, v29
    v_cvt_pk_bf16_f32 v45, v30, v31
    ds_write_b64 v48, v[44:45] offset:15232
    v_pk_mul_f32 v[52:53], v[28:29], v[20:21] op_sel:[0,0] op_sel_hi:[1,0]
    v_pk_mul_f32 v[54:55], v[30:31], v[22:23] op_sel:[0,0] op_sel_hi:[1,0]
    v_pk_fma_f32 v[28:29], v[28:29], v[20:21], v[52:53] op_sel:[1,1,0] op_sel_hi:[0,1,1] neg_lo:[1,0,0]
    v_pk_fma_f32 v[30:31], v[30:31], v[22:23], v[54:55] op_sel:[1,1,0] op_sel_hi:[0,1,1] neg_lo:[1,0,0]
    v_cvt_pk_bf16_f32 v46, v32, v33
    v_cvt_pk_bf16_f32 v47, v34, v35
    ds_write_b64 v48, v[46:47] offset:13600
    v_pk_mul_f32 v[40:41], v[32:33], v[20:21] op_sel:[0,0] op_sel_hi:[1,0]
    v_pk_mul_f32 v[42:43], v[34:35], v[22:23] op_sel:[0,0] op_sel_hi:[1,0]
    v_pk_fma_f32 v[32:33], v[32:33], v[20:21], v[40:41] op_sel:[1,1,0] op_sel_hi:[0,1,1] neg_lo:[1,0,0]
    v_pk_fma_f32 v[34:35], v[34:35], v[22:23], v[42:43] op_sel:[1,1,0] op_sel_hi:[0,1,1] neg_lo:[1,0,0]
    v_cvt_pk_bf16_f32 v44, v28, v29
    v_cvt_pk_bf16_f32 v45, v30, v31
    ds_write_b64 v48, v[44:45] offset:19584
    v_pk_mul_f32 v[52:53], v[28:29], v[20:21] op_sel:[0,0] op_sel_hi:[1,0]
    v_pk_mul_f32 v[54:55], v[30:31], v[22:23] op_sel:[0,0] op_sel_hi:[1,0]
    v_pk_fma_f32 v[28:29], v[28:29], v[20:21], v[52:53] op_sel:[1,1,0] op_sel_hi:[0,1,1] neg_lo:[1,0,0]
    v_pk_fma_f32 v[30:31], v[30:31], v[22:23], v[54:55] op_sel:[1,1,0] op_sel_hi:[0,1,1] neg_lo:[1,0,0]
    v_cvt_pk_bf16_f32 v46, v32, v33
    v_cvt_pk_bf16_f32 v47, v34, v35
    ds_write_b64 v48, v[46:47] offset:17952
    v_pk_mul_f32 v[40:41], v[32:33], v[20:21] op_sel:[0,0] op_sel_hi:[1,0]
    v_pk_mul_f32 v[42:43], v[34:35], v[22:23] op_sel:[0,0] op_sel_hi:[1,0]
    v_pk_fma_f32 v[32:33], v[32:33], v[20:21], v[40:41] op_sel:[1,1,0] op_sel_hi:[0,1,1] neg_lo:[1,0,0]
    v_pk_fma_f32 v[34:35], v[34:35], v[22:23], v[42:43] op_sel:[1,1,0] op_sel_hi:[0,1,1] neg_lo:[1,0,0]
    v_cvt_pk_bf16_f32 v44, v28, v29
    v_cvt_pk_bf16_f32 v45, v30, v31
    ds_write_b64 v48, v[44:45] offset:19040
    v_pk_mul_f32 v[52:53], v[28:29], v[20:21] op_sel:[0,0] op_sel_hi:[1,0]
    v_pk_mul_f32 v[54:55], v[30:31], v[22:23] op_sel:[0,0] op_sel_hi:[1,0]
    v_pk_fma_f32 v[28:29], v[28:29], v[20:21], v[52:53] op_sel:[1,1,0] op_sel_hi:[0,1,1] neg_lo:[1,0,0]
    v_pk_fma_f32 v[30:31], v[30:31], v[22:23], v[54:55] op_sel:[1,1,0] op_sel_hi:[0,1,1] neg_lo:[1,0,0]
    v_cvt_pk_bf16_f32 v46, v32, v33
    v_cvt_pk_bf16_f32 v47, v34, v35
    ds_write_b64 v48, v[46:47] offset:17408
    v_pk_mul_f32 v[40:41], v[32:33], v[20:21] op_sel:[0,0] op_sel_hi:[1,0]
    v_pk_mul_f32 v[42:43], v[34:35], v[22:23] op_sel:[0,0] op_sel_hi:[1,0]
    v_pk_fma_f32 v[32:33], v[32:33], v[20:21], v[40:41] op_sel:[1,1,0] op_sel_hi:[0,1,1] neg_lo:[1,0,0]
    v_pk_fma_f32 v[34:35], v[34:35], v[22:23], v[42:43] op_sel:[1,1,0] op_sel_hi:[0,1,1] neg_lo:[1,0,0]
    s_cmp_lt_u32 s5, 16
    s_cbranch_scc1 L_pm2
    s_lshl_b32 s11, s89, 5
    s_lshr_b32 s59, s47, 1
    s_lshl_b32 s59, s59, 4
    s_add_u32 s11, s11, s59
    v_lshrrev_b32 v127, 2, v1
    v_add_u32 v127, s11, v127
    v_mul_u32_u24 v127, 2752, v127
    v_and_b32 v124, 3, v1
    v_lshlrev_b32 v124, 7, v124
    v_min_u32 v124, 348, v124
    s_mul_i32 s11, s4, 352
    v_add3_u32 v127, v127, v124, s11
    v_min_u32 v127, 1409020, v127
    s_cmp_eq_u32 s14, 0
    s_cselect_b32 s80, s34, s36
    s_cselect_b32 s81, s35, s37
    global_load_dword v238, v127, s[80:81]
L_pm2:
    v_cvt_pk_bf16_f32 v44, v28, v29
    v_cvt_pk_bf16_f32 v45, v30, v31
    ds_write_b64 v48, v[44:45] offset:26656
    v_pk_mul_f32 v[52:53], v[28:29], v[20:21] op_sel:[0,0] op_sel_hi:[1,0]
    v_pk_mul_f32 v[54:55], v[30:31], v[22:23] op_sel:[0,0] op_sel_hi:[1,0]
    v_pk_fma_f32 v[28:29], v[28:29], v[20:21], v[52:53] op_sel:[1,1,0] op_sel_hi:[0,1,1] neg_lo:[1,0,0]
    v_pk_fma_f32 v[30:31], v[30:31], v[22:23], v[54:55] op_sel:[1,1,0] op_sel_hi:[0,1,1] neg_lo:[1,0,0]
    v_cvt_pk_bf16_f32 v46, v32, v33
    v_cvt_pk_bf16_f32 v47, v34, v35
    ds_write_b64 v48, v[46:47] offset:28288
    v_cvt_pk_bf16_f32 v44, v28, v29
    v_cvt_pk_bf16_f32 v45, v30, v31
    ds_write_b64 v48, v[44:45] offset:33184
    v_pk_mul_f32 v[52:53], v[28:29], v[20:21] op_sel:[0,0] op_sel_hi:[1,0]
    v_pk_mul_f32 v[54:55], v[30:31], v[22:23] op_sel:[0,0] op_sel_hi:[1,0]
    v_pk_fma_f32 v[28:29], v[28:29], v[20:21], v[52:53] op_sel:[1,1,0] op_sel_hi:[0,1,1] neg_lo:[1,0,0]
    v_pk_fma_f32 v[30:31], v[30:31], v[22:23], v[54:55] op_sel:[1,1,0] op_sel_hi:[0,1,1] neg_lo:[1,0,0]
    v_cvt_pk_bf16_f32 v46, v28, v29
    v_cvt_pk_bf16_f32 v47, v30, v31
    ds_write_b64 v48, v[46:47] offset:29376
    v_pk_mul_f32 v[52:53], v[28:29], v[20:21] op_sel:[0,0] op_sel_hi:[1,0]
    v_pk_mul_f32 v[54:55], v[30:31], v[22:23] op_sel:[0,0] op_sel_hi:[1,0]
    v_pk_fma_f32 v[28:29], v[28:29], v[20:21], v[52:53] op_sel:[1,1,0] op_sel_hi:[0,1,1] neg_lo:[1,0,0]
    v_pk_fma_f32 v[30:31], v[30:31], v[22:23], v[54:55] op_sel:[1,1,0] op_sel_hi:[0,1,1] neg_lo:[1,0,0]
    v_cvt_pk_bf16_f32 v44, v28, v29
    v_cvt_pk_bf16_f32 v45, v30, v31
    ds_write_b64 v48, v[44:45] offset:26112
    v_pk_mul_f32 v[52:53], v[28:29], v[20:21] op_sel:[0,0] op_sel_hi:[1,0]
    v_pk_mul_f32 v[54:55], v[30:31], v[22:23] op_sel:[0,0] op_sel_hi:[1,0]
    v_pk_fma_f32 v[28:29], v[28:29], v[20:21], v[52:53] op_sel:[1,1,0] op_sel_hi:[0,1,1] neg_lo:[1,0,0]
    v_pk_fma_f32 v[30:31], v[30:31], v[22:23], v[54:55] op_sel:[1,1,0] op_sel_hi:[0,1,1] neg_lo:[1,0,0]
    s_cmp_lt_u32 s5, 16
    s_cbranch_scc0 L_fm2
    s_waitcnt vmcnt(0)
    s_mov_b64 exec, 1
    global_store_dword v126, v125, s[44:45]
    s_mov_b64 exec, -1
L_fm2:
    v_cvt_pk_bf16_f32 v46, v28, v29
    v_cvt_pk_bf16_f32 v47, v30, v31
    ds_write_b64 v48, v[46:47] offset:32096
L_helper:
    v_bfe_u32 v176, v191, s76, 16
    v_add_u32_sdwa v178, s71, v189 dst_sel:DWORD dst_unused:UNUSED_PAD src0_sel:DWORD src1_sel:WORD_0
    v_add_u32_sdwa v179, s70, v188 dst_sel:DWORD dst_unused:UNUSED_PAD src0_sel:DWORD src1_sel:WORD_0
    v_add_u32_sdwa v180, s70, v188 dst_sel:DWORD dst_unused:UNUSED_PAD src0_sel:DWORD src1_sel:WORD_1
    v_add_u32 v176, s71, v176
    s_lshl_b32 s58, s14, 4
    s_lshr_b32 s58, s9, s58
    s_lshl_b32 s58, s58, 16
    s_cmp_eq_u32 s15, 2
    s_cselect_b32 s88, s58, 0
    s_lshl_b32 s58, s47, 9
    s_sub_u32 s58, 88120, s58
    v_lshlrev_b32 v114, 3, v1
    v_sub_u32 v114, s58, v114
    v_and_b32 v115, 3, v1
    v_mul_u32_u24 v115, 20, v115
    v_lshrrev_b32 v116, 2, v1
    v_add_u32 v115, v115, v116
    s_mul_i32 s58, s47, 1280
    v_lshl_add_u32 v115, v115, 4, s58
    s_lshl_b32 s58, s47, 2
    s_add_u32 s58, s58, 96064
    v_mov_b32 v116, s58
    s_lshl_b32 s11, s47, 18
    s_lshl_b32 s58, s6, 2
    s_add_u32 s11, s11, s58
    v_lshl_add_u32 v124, v1, 12, s11
    v_mov_b32 v18, 96096
    s_cmp_eq_u32 s61, 0
    s_cbranch_scc1 L_nofa
    v_lshrrev_b32 v62, 4, v1
    v_and_b32 v63, 15, v1
    v_bfe_u32 v117, v1, 3, 2
    v_lshlrev_b32 v117, 3, v117
    v_lshrrev_b32 v32, 5, v1
    v_lshl_add_u32 v117, v32, 2, v117
    v_bfe_u32 v32, v1, 1, 2
    s_lshl_b32 s58, s47, 7
    v_add3_u32 v117, v117, v32, s58
    v_mul_u32_u24 v117, 2752, v117
    v_and_b32 v32, 1, v1
    v_lshl_add_u32 v117, v32, 4, v117
    s_lshl_b32 s58, s60, 5
    v_add_u32 v117, s58, v117
    s_lshl_b32 s58, s47, 13
    s_add_u32 s84, s58, 98624
    v_lshl_add_u32 v118, v1, 3, s84
    s_lshl_b32 s11, s60, 14
    s_lshl_b32 s58, s47, 8
    s_add_u32 s11, s11, s58
    v_lshl_add_u32 v4, v1, 2, s11
    v_add_u32 v5, 4096, v4
    v_add_u32 v6, 8192, v4
    v_add_u32 v7, 12288, v4
    v_lshl_add_u32 v232, v62, 4, s58
    s_add_u32 s58, s58, 97600
    v_lshl_add_u32 v122, v1, 1, s58
    v_lshl_add_u32 v123, v32, 5, s58
    v_mov_b32 v33, 96160
    s_mov_b32 s58, 0x00300003
    s_mov_b32 s59, 0x30000300
    v_cndmask_b32 v123, v33, v123, s[58:59]
    s_lshl_b32 s58, s47, 2
    s_add_u32 s58, s58, 96576
    v_lshl_add_u32 v120, v63, 5, s58
    v_and_b32 v121, 31, v1
    v_lshlrev_b32 v121, 5, v121
    v_add_u32 v121, 96576, v121
    s_lshl_b32 s11, s60, 12
    s_add_u32 s11, s11, 65536
    v_subrev_u32 v126, 256, v0
    v_lshl_add_u32 v126, v126, 4, s11
    s_lshl_b32 s58, s4, 8
    s_lshl_b32 s59, s47, 6
    s_add_u32 s58, s58, s59
    s_lshl_b32 s59, s5, 2
    s_add_u32 s58, s58, s59
    s_add_u32 s58, s58, 40876
    v_mov_b32 v12, s58
    v_mov_b32 v151, 96128
    v_mov_b32 v152, 1
    v_mov_b32 v159, s7
    s_mov_b32 s85, 0x07060501
    s_mov_b32 s86, 0x07060502
    s_mov_b32 s87, 0x07060503
    s_mov_b32 s94, 0x05040100
    s_mov_b32 s95, 0x07060302
    v_mov_b32 v96, 0x3f803f80
    v_mov_b32 v97, 0x3f803f80
    v_mov_b32 v98, 0x3f803f80
    v_mov_b32 v99, 0x3f803f80
    v_mov_b32 v100, 0x3f803f80
    v_mov_b32 v101, 0x3f803f80
    v_mov_b32 v102, 0x3f803f80
    v_mov_b32 v103, 0x3f803f80
    v_mov_b32 v104, 0x3f803f80
    v_mov_b32 v105, 0x3f803f80
    v_mov_b32 v106, 0x3f803f80
    v_mov_b32 v107, 0x3f803f80
    v_mov_b32 v108, 0x3f803f80
    v_mov_b32 v109, 0x3f803f80
    v_mov_b32 v110, 0x3f803f80
    v_mov_b32 v111, 0x3f803f80
L_nofa:
    s_waitcnt lgkmcnt(0)
    s_barrier
L_hgemm:
    global_load_dword v234, v112, s[44:45] sc1
    global_load_dword v235, v112, s[44:45] offset:128 sc1
    global_load_dwordx4 v[240:243], v2, s[44:45] sc1
    global_load_dwordx4 v[244:247], v2, s[44:45] offset:1024 sc1
    global_load_dwordx4 v[248:251], v3, s[44:45] sc1
    global_load_dwordx4 v[252:255], v3, s[44:45] offset:1024 sc1
    ds_read_b128 v[20:23], v178 offset:0
    ds_read_b128 v[24:27], v176 offset:0
    ds_read_b128 v[28:31], v178 offset:64
    ds_read_b128 v[32:35], v176 offset:64
    ds_read_b128 v[36:39], v178 offset:128
    ds_read_b128 v[40:43], v176 offset:128
    ds_read_b128 v[44:47], v178 offset:192
    ds_read_b128 v[48:51], v176 offset:192
    ds_read_b128 v[52:55], v178 offset:256
    ds_read_b128 v[56:59], v176 offset:256
    ds_read_b128 v[60:63], v178 offset:320
    ds_read_b128 v[64:67], v176 offset:320
    s_waitcnt lgkmcnt(10)
    v_mfma_f32_16x16x32_bf16 v[184:187], v[24:27], v[20:23], 0
    ds_read_b128 v[68:71], v178 offset:384
    ds_read_b128 v[72:75], v176 offset:384
    s_waitcnt lgkmcnt(10)
    v_mfma_f32_16x16x32_bf16 v[184:187], v[32:35], v[28:31], v[184:187]
    ds_read_b128 v[76:79], v178 offset:448
    ds_read_b128 v[80:83], v176 offset:448
    s_waitcnt lgkmcnt(10)
    v_mfma_f32_16x16x32_bf16 v[184:187], v[40:43], v[36:39], v[184:187]
    s_waitcnt lgkmcnt(8)
    v_mfma_f32_16x16x32_bf16 v[184:187], v[48:51], v[44:47], v[184:187]
    s_waitcnt lgkmcnt(6)
    v_mfma_f32_16x16x32_bf16 v[184:187], v[56:59], v[52:55], v[184:187]
    s_waitcnt lgkmcnt(4)
    v_mfma_f32_16x16x32_bf16 v[184:187], v[64:67], v[60:63], v[184:187]
    s_waitcnt lgkmcnt(2)
    v_mfma_f32_16x16x32_bf16 v[184:187], v[72:75], v[68:71], v[184:187]
    s_waitcnt lgkmcnt(0)
    v_mfma_f32_16x16x32_bf16 v[184:187], v[80:83], v[76:79], v[184:187]
    s_waitcnt vmcnt(4)
    v_xor_b32 v234, s46, v234
    v_xor_b32 v235, s46, v235
    v_or_b32 v234, v234, v235
    v_cmp_ne_u32 vcc, 0, v234
    s_nop 0
    s_cbranch_vccnz L_ft0
    s_mov_b32 s98, 1
    global_load_dwordx4 v[128:131], v113, s[44:45] offset:-2048 sc1
    global_load_dwordx4 v[132:135], v113, s[44:45] offset:2048 sc1
    s_branch L_ft1
L_ft0:
    global_load_dword v234, v112, s[44:45] sc1
    global_load_dword v235, v112, s[44:45] offset:128 sc1
L_ft1:
    s_mov_b64 exec, 1
    v_add_f32 v184, s88, v184
    s_mov_b64 exec, -1
    v_cvt_pk_bf16_f32 v20, v184, v185
    v_cvt_pk_bf16_f32 v21, v186, v187
    v_cvt_pk_bf16_f32 v22, v185, v186
    ds_write_b64 v179, v[20:21]
    ds_write_b32 v180, v20 offset:4644
    ds_write_b32 v179, v21 offset:4640
    ds_write_b16 v180, v20 offset:2326
    ds_write_b32 v179, v22 offset:2320
    ds_write_b16_d16_hi v179, v21 offset:2324
    ds_write_b16 v180, v20 offset:6962
    ds_write_b32 v180, v22 offset:6964
    ds_write_b16_d16_hi v179, v21 offset:6960
    s_mov_b64 exec, 1
    ds_add_u32 v182, v183
    s_mov_b64 exec, -1
    s_mov_b32 s11, 0
    s_cmp_eq_u32 s61, 0
    s_cbranch_scc1 L_hw2
    s_cmp_eq_u32 s98, 0
    s_cbranch_scc1 L_hw2
    s_mov_b32 m0, s84
    s_mov_b32 s98, 2
    global_load_lds_dwordx4 v117, s[34:35]
    s_add_u32 m0, m0, 1024
    s_nop 0
    global_load_lds_dwordx4 v117, s[36:37]
    s_add_u32 m0, m0, 1024
    v_add_u32 v117, 88064, v117
    global_load_lds_dwordx4 v117, s[34:35]
    s_add_u32 m0, m0, 1024
    s_nop 0
    global_load_lds_dwordx4 v117, s[36:37]
    s_add_u32 m0, m0, 1024
    v_add_u32 v117, 88064, v117
    s_waitcnt vmcnt(6)
    s_branch L_hchk
L_hw2:
    s_waitcnt vmcnt(2)
    s_branch L_hchk
L_hpoll:
    s_waitcnt vmcnt(0)
L_hchk:
    v_xor_b32 v48, s7, v243
    v_xor_b32 v49, s7, v247
    v_xor_b32 v50, s7, v251
    v_xor_b32 v51, s7, v255
    v_or_b32 v48, v48, v49
    v_or3_b32 v48, v48, v50, v51
    v_cmp_lt_u32 vcc, 15, v48
    s_add_u32 s11, s11, 1
    s_cmp_gt_u32 s11, 100000
    s_cbranch_scc1 L_hpoll_done
    s_cbranch_vccz L_hpoll_done
    global_load_dwordx4 v[240:243], v2, s[44:45] sc1
    global_load_dwordx4 v[244:247], v2, s[44:45] offset:1024 sc1
    global_load_dwordx4 v[248:251], v3, s[44:45] sc1
    global_load_dwordx4 v[252:255], v3, s[44:45] offset:1024 sc1
    s_branch L_hpoll
L_hpoll_done:
    s_cmp_eq_u32 s98, 0
    s_cbranch_scc1 L_xretry
L_gotx:
    s_cmp_eq_u32 s61, 0
    s_cbranch_scc1 L_de1
    s_cmp_eq_u32 s98, 2
    s_cbranch_scc1 L_de1
    s_mov_b32 m0, s84
    s_nop 0
    global_load_lds_dwordx4 v117, s[34:35]
    s_add_u32 m0, m0, 1024
    s_nop 0
    global_load_lds_dwordx4 v117, s[36:37]
    s_add_u32 m0, m0, 1024
    v_add_u32 v117, 88064, v117
    global_load_lds_dwordx4 v117, s[34:35]
    s_add_u32 m0, m0, 1024
    s_nop 0
    global_load_lds_dwordx4 v117, s[36:37]
    s_add_u32 m0, m0, 1024
    v_add_u32 v117, 88064, v117
L_de1:
    v_and_b32 v48, s56, v240
    v_lshlrev_b32 v56, 16, v240
    v_rcp_f32 v48, v48
    v_and_b32 v49, s56, v241
    v_lshlrev_b32 v57, 16, v241
    v_rcp_f32 v49, v49
    v_and_b32 v50, s56, v244
    v_lshlrev_b32 v58, 16, v244
    v_rcp_f32 v50, v50
    v_and_b32 v51, s56, v245
    v_lshlrev_b32 v59, 16, v245
    v_rcp_f32 v51, v51
    v_and_b32 v52, s56, v248
    v_lshlrev_b32 v60, 16, v248
    v_rcp_f32 v52, v52
    v_and_b32 v53, s56, v249
    v_lshlrev_b32 v61, 16, v249
    v_rcp_f32 v53, v53
    v_and_b32 v54, s56, v252
    v_lshlrev_b32 v62, 16, v252
    v_rcp_f32 v54, v54
    v_and_b32 v55, s56, v253
    v_lshlrev_b32 v63, 16, v253
    v_rcp_f32 v55, v55
    v_pk_mul_f32 v[56:57], v[56:57], v[48:49]
    v_pk_mul_f32 v[58:59], v[58:59], v[50:51]
    v_pk_mul_f32 v[60:61], v[60:61], v[52:53]
    v_pk_mul_f32 v[62:63], v[62:63], v[54:55]
    v_xor_b32 v20, s46, v243
    v_xor_b32 v21, s46, v251
    v_or_b32 v20, v20, v21
    v_bfe_u32 v21, v1, 1, 3
    v_cmp_eq_u32 s[58:59], s4, v21
    v_cmp_ne_u32 vcc, 0, v20
    s_nop 0
    s_and_b64 vcc, vcc, s[58:59]
    s_cbranch_scc0 L_novote
    v_mov_b32 v20, 1
    ds_write_b32 v18, v20 offset:40
L_novote:
    s_waitcnt vmcnt(4)
    s_cmp_eq_u32 s61, 0
    s_cbranch_scc1 L_nplain
    global_load_lds_dwordx4 v117, s[34:35]
    s_add_u32 m0, m0, 1024
    v_lshlrev_b32 v32, 16, v128
    v_and_b32 v36, s56, v128
    v_lshlrev_b32 v33, 16, v129
    v_and_b32 v37, s56, v129
    v_lshlrev_b32 v34, 16, v130
    v_and_b32 v38, s56, v130
    v_lshlrev_b32 v35, 16, v131
    v_and_b32 v39, s56, v131
    v_lshlrev_b32 v40, 16, v132
    global_load_lds_dwordx4 v117, s[36:37]
    s_add_u32 m0, m0, 1024
    v_add_u32 v117, 88064, v117
    v_and_b32 v44, s56, v132
    v_lshlrev_b32 v41, 16, v133
    v_and_b32 v45, s56, v133
    v_lshlrev_b32 v42, 16, v134
    v_and_b32 v46, s56, v134
    v_lshlrev_b32 v43, 16, v135
    v_and_b32 v47, s56, v135
    v_pk_fma_f32 v[64:65], v[32:33], v[48:49], v[56:57] neg_lo:[0,0,1] neg_hi:[0,0,1]
    v_pk_fma_f32 v[66:67], v[34:35], v[50:51], v[58:59] neg_lo:[0,0,1] neg_hi:[0,0,1]
    global_load_lds_dwordx4 v117, s[34:35]
    s_add_u32 m0, m0, 1024
    v_pk_fma_f32 v[68:69], v[36:37], v[48:49], v[56:57] neg_lo:[0,0,1] neg_hi:[0,0,1]
    v_pk_fma_f32 v[70:71], v[38:39], v[50:51], v[58:59] neg_lo:[0,0,1] neg_hi:[0,0,1]
    v_pk_fma_f32 v[72:73], v[40:41], v[52:53], v[60:61] neg_lo:[0,0,1] neg_hi:[0,0,1]
    v_pk_fma_f32 v[74:75], v[42:43], v[54:55], v[62:63] neg_lo:[0,0,1] neg_hi:[0,0,1]
    v_pk_fma_f32 v[76:77], v[44:45], v[52:53], v[60:61] neg_lo:[0,0,1] neg_hi:[0,0,1]
    v_pk_fma_f32 v[78:79], v[46:47], v[54:55], v[62:63] neg_lo:[0,0,1] neg_hi:[0,0,1]
    v_cvt_pk_bf16_f32 v80, v67, v66
    v_cvt_pk_bf16_f32 v81, v65, v64
    ds_write_b64 v114, v[80:81] offset:2048
    global_load_lds_dwordx4 v117, s[36:37]
    v_cvt_pk_bf16_f32 v82, v71, v70
    v_cvt_pk_bf16_f32 v83, v69, v68
    ds_write_b64 v114, v[82:83] offset:6656
    v_cvt_pk_bf16_f32 v84, v75, v74
    v_cvt_pk_bf16_f32 v85, v73, v72
    ds_write_b64 v114, v[84:85] offset:0
    v_cvt_pk_bf16_f32 v86, v79, v78
    v_cvt_pk_bf16_f32 v87, v77, v76
    ds_write_b64 v114, v[86:87] offset:4608
    s_branch L_njoin
L_nplain:
    s_waitcnt vmcnt(0)
    v_lshlrev_b32 v32, 16, v128
    v_and_b32 v36, s56, v128
    v_lshlrev_b32 v33, 16, v129
    v_and_b32 v37, s56, v129
    v_lshlrev_b32 v34, 16, v130
    v_and_b32 v38, s56, v130
    v_lshlrev_b32 v35, 16, v131
    v_and_b32 v39, s56, v131
    v_lshlrev_b32 v40, 16, v132
    v_and_b32 v44, s56, v132
    v_lshlrev_b32 v41, 16, v133
    v_and_b32 v45, s56, v133
    v_lshlrev_b32 v42, 16, v134
    v_and_b32 v46, s56, v134
    v_lshlrev_b32 v43, 16, v135
    v_and_b32 v47, s56, v135
    v_pk_fma_f32 v[64:65], v[32:33], v[48:49], v[56:57] neg_lo:[0,0,1] neg_hi:[0,0,1]
    v_pk_fma_f32 v[66:67], v[34:35], v[50:51], v[58:59] neg_lo:[0,0,1] neg_hi:[0,0,1]
    v_pk_fma_f32 v[68:69], v[36:37], v[48:49], v[56:57] neg_lo:[0,0,1] neg_hi:[0,0,1]
    v_pk_fma_f32 v[70:71], v[38:39], v[50:51], v[58:59] neg_lo:[0,0,1] neg_hi:[0,0,1]
    v_pk_fma_f32 v[72:73], v[40:41], v[52:53], v[60:61] neg_lo:[0,0,1] neg_hi:[0,0,1]
    v_pk_fma_f32 v[74:75], v[42:43], v[54:55], v[62:63] neg_lo:[0,0,1] neg_hi:[0,0,1]
    v_pk_fma_f32 v[76:77], v[44:45], v[52:53], v[60:61] neg_lo:[0,0,1] neg_hi:[0,0,1]
    v_pk_fma_f32 v[78:79], v[46:47], v[54:55], v[62:63] neg_lo:[0,0,1] neg_hi:[0,0,1]
    v_cvt_pk_bf16_f32 v80, v67, v66
    v_cvt_pk_bf16_f32 v81, v65, v64
    ds_write_b64 v114, v[80:81] offset:2048
    v_cvt_pk_bf16_f32 v82, v71, v70
    v_cvt_pk_bf16_f32 v83, v69, v68
    ds_write_b64 v114, v[82:83] offset:6656
    v_cvt_pk_bf16_f32 v84, v75, v74
    v_cvt_pk_bf16_f32 v85, v73, v72
    ds_write_b64 v114, v[84:85] offset:0
    v_cvt_pk_bf16_f32 v86, v79, v78
    v_cvt_pk_bf16_f32 v87, v77, v76
    ds_write_b64 v114, v[86:87] offset:4608
L_njoin:
    s_mov_b64 exec, 1
    ds_add_u32 v182, v183 offset:8
    s_mov_b64 exec, -1
    s_cmp_eq_u32 s61, 0
    s_cbranch_scc1 L_noffn1
    s_setprio 1
    s_mov_b32 s11, 0
    s_mov_b32 s80, 0x00030003
    s_mov_b32 s81, 0x00030003
    s_mov_b32 s82, 0x00010001
    s_mov_b32 s83, 0x00010001
    s_movk_i32 s92, 0x7ff
L_kcw:
    ds_read_b32 v19, v182 offset:12
    ds_read_b128 v[20:23], v18
    ds_read_b128 v[24:27], v18 offset:16
    s_add_u32 s11, s11, 1
    s_waitcnt lgkmcnt(2)
    v_readfirstlane_b32 s58, v19
    s_nop 0
    s_cmp_ge_u32 s58, 4
    s_cbranch_scc1 L_kcw_done
    s_sleep 1
    s_cmp_lt_u32 s11, 4000000
    s_cbranch_scc1 L_kcw
L_kcw_done:
    s_waitcnt lgkmcnt(0)
    v_min_u32 v19, v20, v22
    v_max_u32 v16, v20, v22
    v_min_u32 v20, v24, v26
    v_max_u32 v22, v24, v26
    v_max3_u32 v17, v21, v23, v19
    v_max3_u32 v20, v25, v27, v20
    v_min_u32 v19, v16, v22
    v_max3_u32 v17, v17, v20, v19
    s_mov_b64 exec, s[82:83]
    v_max_u32 v17, v16, v22
    s_mov_b64 exec, s[80:81]
    v_bfi_b32 v17, v17, 0, s92
    v_lshl_add_u32 v21, v17, 10, v232
    global_load_dwordx4 v[96:99], v21, s[16:17]
    global_load_dwordx4 v[100:103], v21, s[16:17] offset:64
    global_load_dwordx4 v[104:107], v21, s[16:17] offset:128
    global_load_dwordx4 v[108:111], v21, s[16:17] offset:192
    s_mov_b64 exec, 3
    v_and_b32 v22, 0x700, v17
    v_and_b32 v23, 2, v17
    v_and_b32 v24, 0xfd, v17
    v_lshlrev_b32 v22, 3, v22
    v_lshl_add_u32 v22, v23, 9, v22
    v_lshl_add_u32 v22, v24, 2, v22
    v_add_u32 v22, 2048, v22
    global_load_dword v236, v22, s[44:45] offset:2048 sc1
    s_mov_b64 exec, -1
    s_branch L_ffn1j
L_noffn1:
    s_cmp_lt_u32 s5, 16
    s_cbranch_scc0 L_nowdpf
    s_mul_i32 s11, s4, 1408
    s_mul_i32 s58, s5, 88
    s_add_u32 s11, s11, s58
    s_mul_i32 s58, s47, 22
    s_add_u32 s11, s11, s58
    v_min_u32 v20, 21, v1
    v_add_u32 v20, s11, v20
    v_lshlrev_b32 v20, 7, v20
    v_min_u32 v20, 1409020, v20
    global_load_dword v238, v20, s[38:39]
L_nowdpf:
    v_mul_f32 v48, s100, v64
    v_mul_f32 v49, s100, v65
    v_mul_f32 v50, s100, v66
    v_mul_f32 v51, s100, v67
    v_mul_f32 v52, s100, v68
    v_mul_f32 v53, s100, v69
    v_mul_f32 v54, s100, v70
    v_mul_f32 v55, s100, v71
    v_exp_f32 v48, v48
    v_exp_f32 v49, v49
    v_exp_f32 v50, v50
    v_exp_f32 v51, v51
    v_exp_f32 v52, v52
    v_exp_f32 v53, v53
    v_exp_f32 v54, v54
    v_exp_f32 v55, v55
    v_add_f32 v48, 1.0, v48
    v_add_f32 v49, 1.0, v49
    v_add_f32 v50, 1.0, v50
    v_add_f32 v51, 1.0, v51
    v_add_f32 v52, 1.0, v52
    v_add_f32 v53, 1.0, v53
    v_add_f32 v54, 1.0, v54
    v_add_f32 v55, 1.0, v55
    v_rcp_f32 v48, v48
    v_rcp_f32 v49, v49
    v_rcp_f32 v50, v50
    v_rcp_f32 v51, v51
    v_rcp_f32 v52, v52
    v_rcp_f32 v53, v53
    v_rcp_f32 v54, v54
    v_rcp_f32 v55, v55
    v_mul_f32 v48, v48, v64
    v_mul_f32 v49, v49, v65
    v_mul_f32 v50, v50, v66
    v_mul_f32 v51, v51, v67
    v_mul_f32 v52, v52, v68
    v_mul_f32 v53, v53, v69
    v_mul_f32 v54, v54, v70
    v_mul_f32 v55, v55, v71
    v_mul_f32 v56, s100, v72
    v_mul_f32 v57, s100, v73
    v_mul_f32 v58, s100, v74
    v_mul_f32 v59, s100, v75
    v_mul_f32 v60, s100, v76
    v_mul_f32 v61, s100, v77
    v_mul_f32 v62, s100, v78
    v_mul_f32 v63, s100, v79
    v_exp_f32 v56, v56
    v_exp_f32 v57, v57
    v_exp_f32 v58, v58
    v_exp_f32 v59, v59
    v_exp_f32 v60, v60
    v_exp_f32 v61, v61
    v_exp_f32 v62, v62
    v_exp_f32 v63, v63
    v_add_f32 v56, 1.0, v56
    v_add_f32 v57, 1.0, v57
    v_add_f32 v58, 1.0, v58
    v_add_f32 v59, 1.0, v59
    v_add_f32 v60, 1.0, v60
    v_add_f32 v61, 1.0, v61
    v_add_f32 v62, 1.0, v62
    v_add_f32 v63, 1.0, v63
    v_rcp_f32 v56, v56
    v_rcp_f32 v57, v57
    v_rcp_f32 v58, v58
    v_rcp_f32 v59, v59
    v_rcp_f32 v60, v60
    v_rcp_f32 v61, v61
    v_rcp_f32 v62, v62
    v_rcp_f32 v63, v63
    v_mul_f32 v56, v56, v72
    v_mul_f32 v57, v57, v73
    v_mul_f32 v58, v58, v74
    v_mul_f32 v59, v59, v75
    v_mul_f32 v60, v60, v76
    v_mul_f32 v61, v61, v77
    v_mul_f32 v62, v62, v78
    v_mul_f32 v63, v63, v79
    s_lshl_b32 s58, s47, 8
    s_sub_u32 s58, 2047, s58
    v_lshlrev_b32 v16, 2, v1
    v_sub_u32 v16, s58, v16
    v_subrev_u32 v17, 1, v16
    s_lshl_b32 s58, s47, 3
    s_add_u32 s58, s58, 96096
    v_mov_b32 v19, s58
    v_lshl_or_b32 v20, v242, 16, v16
    v_and_or_b32 v21, v242, s56, v17
    v_lshl_or_b32 v22, v246, 16, v16
    v_and_or_b32 v23, v246, s56, v17
    v_subrev_u32 v22, 2, v22
    v_subrev_u32 v23, 2, v23
    v_lshl_or_b32 v24, v250, 16, v16
    v_and_or_b32 v25, v250, s56, v17
    v_subrev_u32 v24, 1024, v24
    v_subrev_u32 v25, 1024, v25
    v_lshl_or_b32 v26, v254, 16, v16
    v_and_or_b32 v27, v254, s56, v17
    v_subrev_u32 v26, 1026, v26
    v_subrev_u32 v27, 1026, v27
    v_min_u32 v96, v20, v21
    v_max_u32 v20, v20, v21
    v_min_u32 v97, v22, v23
    v_max_u32 v22, v22, v23
    v_min_u32 v98, v24, v25
    v_max_u32 v24, v24, v25
    v_min_u32 v99, v26, v27
    v_max_u32 v26, v26, v27
    v_min_u32 v21, v20, v22
    v_max_u32 v20, v20, v22
    v_min_u32 v25, v24, v26
    v_max_u32 v24, v24, v26
    v_max3_u32 v21, v21, v96, v97
    v_max3_u32 v25, v25, v98, v99
    v_min_u32 v100, v20, v24
    v_max_u32 v28, v20, v24
    v_max3_u32 v29, v21, v25, v100
    s_nop 0
    v_min_u32_dpp v100, v28, v28 row_ror:8 row_mask:0xf bank_mask:0xf
    v_max_u32_dpp v31, v29, v29 row_ror:8 row_mask:0xf bank_mask:0xf
    v_max_u32_dpp v28, v28, v28 row_ror:8 row_mask:0xf bank_mask:0xf
    v_max_u32 v29, v31, v100
    s_nop 0
    v_min_u32_dpp v100, v28, v28 row_ror:4 row_mask:0xf bank_mask:0xf
    v_max_u32_dpp v31, v29, v29 row_ror:4 row_mask:0xf bank_mask:0xf
    v_max_u32_dpp v28, v28, v28 row_ror:4 row_mask:0xf bank_mask:0xf
    v_max_u32 v29, v31, v100
    s_nop 0
    v_min_u32_dpp v100, v28, v28 row_ror:2 row_mask:0xf bank_mask:0xf
    v_max_u32_dpp v31, v29, v29 row_ror:2 row_mask:0xf bank_mask:0xf
    v_max_u32_dpp v28, v28, v28 row_ror:2 row_mask:0xf bank_mask:0xf
    v_max_u32 v29, v31, v100
    s_nop 0
    v_min_u32_dpp v100, v28, v28 row_ror:1 row_mask:0xf bank_mask:0xf
    v_max_u32_dpp v31, v29, v29 row_ror:1 row_mask:0xf bank_mask:0xf
    v_max_u32_dpp v28, v28, v28 row_ror:1 row_mask:0xf bank_mask:0xf
    v_max_u32 v29, v31, v100
    v_mov_b32 v30, v28
    v_mov_b32 v31, v29
    s_nop 0
    v_permlane16_swap_b32 v28, v30
    v_permlane16_swap_b32 v29, v31
    v_min_u32 v100, v28, v30
    v_max_u32 v28, v28, v30
    v_max3_u32 v29, v29, v31, v100
    v_mov_b32 v30, v28
    v_mov_b32 v31, v29
    s_nop 0
    v_permlane32_swap_b32 v28, v30
    v_permlane32_swap_b32 v29, v31
    v_min_u32 v100, v28, v30
    v_max_u32 v28, v28, v30
    v_max3_u32 v29, v29, v31, v100
    s_mov_b64 exec, 1
    ds_write_b64 v19, v[28:29]
    ds_add_u32 v182, v183 offset:12
    s_mov_b64 exec, -1
    s_branch L_after_ffn
L_ffn1j:
    s_waitcnt vmcnt(5)
    ds_read_b64_tr_b16 v[168:169], v118 offset:0
    ds_read_b64_tr_b16 v[170:171], v118 offset:512
    ds_read_b64_tr_b16 v[172:173], v118 offset:1024
    ds_read_b64_tr_b16 v[174:175], v118 offset:1536
    ds_read_b64_tr_b16 v[176:177], v118 offset:2048
    ds_read_b64_tr_b16 v[178:179], v118 offset:2560
    ds_read_b64_tr_b16 v[180:181], v118 offset:3072
    ds_read_b64_tr_b16 v[182:183], v118 offset:3584
    ds_read_b64_tr_b16 v[184:185], v118 offset:4096
    ds_read_b64_tr_b16 v[186:187], v118 offset:4608
    ds_read_b64_tr_b16 v[188:189], v118 offset:5120
    ds_read_b64_tr_b16 v[190:191], v118 offset:5632
    ds_read_b64_tr_b16 v[192:193], v118 offset:6144
    ds_read_b64_tr_b16 v[194:195], v118 offset:6656
    ds_read_b64_tr_b16 v[196:197], v118 offset:7168
    ds_read_b64_tr_b16 v[198:199], v118 offset:7680
    v_mul_f32 v56, s100, v72
    global_load_dword v200, v4, s[38:39] offset:0
    v_mul_f32 v57, s100, v73
    v_mul_f32 v58, s100, v74
    global_load_dword v201, v4, s[38:39] offset:1024
    v_mul_f32 v59, s100, v75
    v_mul_f32 v60, s100, v76
    global_load_dword v202, v4, s[38:39] offset:2048
    v_mul_f32 v61, s100, v77
    v_mul_f32 v62, s100, v78
    global_load_dword v203, v4, s[38:39] offset:3072
    v_mul_f32 v63, s100, v79
    v_exp_f32 v56, v56
    global_load_dword v204, v5, s[38:39] offset:0
    v_exp_f32 v57, v57
    v_exp_f32 v58, v58
    global_load_dword v205, v5, s[38:39] offset:1024
    v_exp_f32 v59, v59
    v_exp_f32 v60, v60
    global_load_dword v206, v5, s[38:39] offset:2048
    v_exp_f32 v61, v61
    v_exp_f32 v62, v62
    global_load_dword v207, v5, s[38:39] offset:3072
    v_exp_f32 v63, v63
    v_add_f32 v56, 1.0, v56
    global_load_dword v208, v6, s[38:39] offset:0
    v_add_f32 v57, 1.0, v57
    v_add_f32 v58, 1.0, v58
    global_load_dword v209, v6, s[38:39] offset:1024
    v_add_f32 v59, 1.0, v59
    v_add_f32 v60, 1.0, v60
    global_load_dword v210, v6, s[38:39] offset:2048
    v_add_f32 v61, 1.0, v61
    v_add_f32 v62, 1.0, v62
    global_load_dword v211, v6, s[38:39] offset:3072
    v_add_f32 v63, 1.0, v63
    v_rcp_f32 v56, v56
    global_load_dword v212, v7, s[38:39] offset:0
    v_rcp_f32 v57, v57
    v_rcp_f32 v58, v58
    global_load_dword v213, v7, s[38:39] offset:1024
    v_rcp_f32 v59, v59
    v_rcp_f32 v60, v60
    global_load_dword v214, v7, s[38:39] offset:2048
    v_rcp_f32 v61, v61
    v_rcp_f32 v62, v62
    global_load_dword v215, v7, s[38:39] offset:3072
    v_rcp_f32 v63, v63
    v_mul_f32 v56, v56, v72
    v_mul_f32 v57, v57, v73
    v_mul_f32 v58, v58, v74
    v_mul_f32 v59, v59, v75
    v_mul_f32 v60, v60, v76
    v_mul_f32 v61, v61, v77
    v_mul_f32 v62, v62, v78
    v_mul_f32 v63, v63, v79
    s_waitcnt vmcnt(16)
    v_readlane_b32 s92, v236, 0
    v_readlane_b32 s93, v236, 1
    s_waitcnt lgkmcnt(0)
    v_mfma_f32_16x16x32_bf16 v[136:139], v[96:99], v[168:171], 0
    v_mfma_f32_16x16x32_bf16 v[140:143], v[96:99], v[172:175], 0
    v_mfma_f32_16x16x32_bf16 v[136:139], v[100:103], v[176:179], v[136:139]
    v_mfma_f32_16x16x32_bf16 v[140:143], v[100:103], v[180:183], v[140:143]
    v_mfma_f32_16x16x32_bf16 v[136:139], v[104:107], v[184:187], v[136:139]
    v_mfma_f32_16x16x32_bf16 v[140:143], v[104:107], v[188:191], v[140:143]
    v_mfma_f32_16x16x32_bf16 v[136:139], v[108:111], v[192:195], v[136:139]
    v_mfma_f32_16x16x32_bf16 v[140:143], v[108:111], v[196:199], v[140:143]
    s_lshl_b32 s80, s92, 16
    s_lshl_b32 s81, s93, 16
    s_and_b32 s92, s92, 0xffff0000
    s_and_b32 s93, s93, 0xffff0000
    s_mov_b32 s58, 0xffff0000
    s_mov_b32 s59, 0xffff0000
    v_rcp_f32 v19, s92
    s_mov_b64 exec, s[58:59]
    v_rcp_f32 v19, s93
    s_mov_b64 exec, 0xffff
    v_fma_f32 v136, -s80, v138, v136
    v_fma_f32 v137, -s81, v138, v137
    v_fma_f32 v140, -s80, v142, v140
    v_fma_f32 v141, -s81, v142, v141
    ds_write_b32 v120, v136
    ds_write_b32 v120, v137 offset:512
    ds_write_b32 v120, v140 offset:16
    ds_write_b32 v120, v141 offset:528
    s_mov_b64 exec, 1
    ds_add_u32 v151, v152
    s_mov_b64 exec, -1
    s_waitcnt vmcnt(0)
    v_perm_b32 v216, v201, v200, s94
    v_perm_b32 v224, v201, v200, s95
    v_perm_b32 v217, v203, v202, s94
    v_perm_b32 v225, v203, v202, s95
    v_perm_b32 v218, v205, v204, s94
    v_perm_b32 v226, v205, v204, s95
    v_perm_b32 v219, v207, v206, s94
    v_perm_b32 v227, v207, v206, s95
    v_perm_b32 v220, v209, v208, s94
    v_perm_b32 v228, v209, v208, s95
    v_perm_b32 v221, v211, v210, s94
    v_perm_b32 v229, v211, v210, s95
    v_perm_b32 v222, v213, v212, s94
    v_perm_b32 v230, v213, v212, s95
    v_perm_b32 v223, v215, v214, s94
    v_perm_b32 v231, v215, v214, s95
    v_mul_f32 v18, s100, v19
    v_mul_f32 v19, v19, v19
    s_mov_b32 s11, 0
L_fs:
    ds_read_b32 v20, v151
    ds_read_b128 v[96:99], v121
    ds_read_b128 v[100:103], v121 offset:16
    s_add_u32 s11, s11, 1
    s_waitcnt lgkmcnt(2)
    v_readfirstlane_b32 s58, v20
    s_nop 0
    s_cmp_ge_u32 s58, 4
    s_cbranch_scc1 L_fs_done
    s_cmp_lt_u32 s11, 4000000
    s_cbranch_scc1 L_fs
L_fs_done:
    s_waitcnt lgkmcnt(1)
    v_add_f32 v96, v96, v98
    v_add_f32 v97, v97, v99
    s_waitcnt lgkmcnt(0)
    v_add_f32 v100, v100, v102
    v_add_f32 v96, v96, v97
    v_add_f32 v101, v101, v103
    v_mul_f32 v24, v96, v18
    v_add_f32 v100, v100, v101
    v_exp_f32 v24, v24
    v_mul_f32 v96, v96, v19
    v_add_f32 v24, 1.0, v24
    v_mul_f32 v96, v96, v100
    v_rcp_f32 v24, v24
    s_nop 0
    v_mul_f32 v20, v96, v24
    v_cvt_pk_bf16_f32 v20, v20, v20
    ds_write_b16 v122, v20
    s_mov_b64 exec, 1
    global_store_dword v12, v159, s[44:45]
    s_mov_b64 exec, -1
    ds_read_b128 v[96:99], v123
    ds_read_b128 v[100:103], v123 offset:16
    s_waitcnt lgkmcnt(1)
    v_mfma_f32_16x16x32_bf16 v[104:107], v[96:99], v[216:219], 0
    v_mfma_f32_16x16x32_bf16 v[108:111], v[96:99], v[224:227], 0
    s_waitcnt lgkmcnt(0)
    v_mfma_f32_16x16x32_bf16 v[104:107], v[100:103], v[220:223], v[104:107]
    v_mfma_f32_16x16x32_bf16 v[108:111], v[100:103], v[228:231], v[108:111]
    s_nop 7
    v_perm_b32 v156, v104, v109, s87
    v_perm_b32 v157, v108, v109, s86
    v_perm_b32 v158, v105, v109, s85
    global_store_dwordx4 v126, v[156:159], s[44:45] sc1
    ds_read_b32 v10, v116 offset:0
    v_mov_b32 v9, 96136
    ds_read_b32 v8, v9
    ds_read_b128 v[16:19], v115 offset:0
    ds_read_b128 v[20:23], v115 offset:10240
    ds_read_b128 v[24:27], v115 offset:20480
    ds_read_b128 v[28:31], v115 offset:30720
    v_mul_f32 v48, s100, v64
    v_mul_f32 v49, s100, v65
    v_mul_f32 v50, s100, v66
    v_mul_f32 v51, s100, v67
    v_mul_f32 v52, s100, v68
    v_mul_f32 v53, s100, v69
    v_mul_f32 v54, s100, v70
    v_mul_f32 v55, s100, v71
    v_exp_f32 v48, v48
    v_exp_f32 v49, v49
    v_exp_f32 v50, v50
    v_exp_f32 v51, v51
    v_exp_f32 v52, v52
    v_exp_f32 v53, v53
    v_exp_f32 v54, v54
    v_exp_f32 v55, v55
    v_add_f32 v48, 1.0, v48
    v_add_f32 v49, 1.0, v49
    v_add_f32 v50, 1.0, v50
    v_add_f32 v51, 1.0, v51
    v_add_f32 v52, 1.0, v52
    v_add_f32 v53, 1.0, v53
    v_add_f32 v54, 1.0, v54
    v_add_f32 v55, 1.0, v55
    v_rcp_f32 v48, v48
    v_rcp_f32 v49, v49
    v_rcp_f32 v50, v50
    v_rcp_f32 v51, v51
    v_rcp_f32 v52, v52
    v_rcp_f32 v53, v53
    v_rcp_f32 v54, v54
    v_rcp_f32 v55, v55
    v_mul_f32 v48, v48, v64
    v_mul_f32 v49, v49, v65
    v_mul_f32 v50, v50, v66
    v_mul_f32 v51, v51, v67
    v_mul_f32 v52, v52, v68
    v_mul_f32 v53, v53, v69
    v_mul_f32 v54, v54, v70
    v_mul_f32 v55, v55, v71
    s_waitcnt lgkmcnt(0)
    v_readfirstlane_b32 s58, v10
    s_nop 0
    s_cmp_ge_u32 s58, 4
    s_cbranch_scc1 L_e0_m
L_after_ffn:
    s_mov_b32 s11, 0
L_e0:
    ds_read_b32 v16, v116 offset:0
    s_add_u32 s11, s11, 1
    s_waitcnt lgkmcnt(0)
    v_readfirstlane_b32 s58, v16
    s_nop 0
    s_cmp_ge_u32 s58, 4
    s_cbranch_scc1 L_e0_done
    s_sleep 1
    s_cmp_lt_u32 s11, 4000000
    s_cbranch_scc1 L_e0
L_e0_done:
    v_mov_b32 v9, 96136
    ds_read_b32 v8, v9
    ds_read_b128 v[16:19], v115 offset:0
    ds_read_b128 v[20:23], v115 offset:10240
    ds_read_b128 v[24:27], v115 offset:20480
    ds_read_b128 v[28:31], v115 offset:30720
L_e0_m:
    s_waitcnt lgkmcnt(4)
    v_readfirstlane_b32 s55, v8
    s_nop 0
    s_cmp_lg_u32 s55, 0
    s_waitcnt lgkmcnt(2)
    v_fma_f32 v32, v16, v48, v32
    v_fma_f32 v33, v17, v49, v33
    v_fma_f32 v34, v18, v50, v34
    v_fma_f32 v35, v19, v51, v35
    v_fma_f32 v36, v20, v52, v36
    v_fma_f32 v37, v21, v53, v37
    v_fma_f32 v38, v22, v54, v38
    v_fma_f32 v39, v23, v55, v39
    s_waitcnt lgkmcnt(0)
    v_fma_f32 v16, v24, v48, v32
    v_fma_f32 v17, v25, v49, v33
    v_fma_f32 v18, v26, v50, v34
    v_fma_f32 v19, v27, v51, v35
    v_fma_f32 v20, v28, v52, v36
    v_fma_f32 v21, v29, v53, v37
    v_fma_f32 v22, v30, v54, v38
    v_fma_f32 v23, v31, v55, v39
    v_cvt_pk_bf16_f32 v88, v16, v20
    v_cvt_pk_bf16_f32 v89, v17, v21
    v_cvt_pk_bf16_f32 v90, v18, v22
    v_cvt_pk_bf16_f32 v91, v19, v23
    s_cbranch_scc1 L_e0_sp
    v_not_b32 v88, v88
    global_store_dwordx4 v113, v[88:91], s[44:45] offset:-2048
L_e0_end:
    s_lshl_b32 s58, s4, 9
    s_add_u32 s80, s58, 36864
    s_lshl_b32 s59, s47, 7
    s_add_u32 s58, s80, s59
    s_lshl_b32 s59, s5, 2
    s_add_u32 s58, s58, s59
    v_mov_b32 v96, s58
    v_mov_b32 v97, s7
    s_cmp_lt_u32 s5, 16
    s_cselect_b32 s54, 1, 0
    s_cmp_lg_u32 s55, 0
    s_cselect_b32 s54, 0, s54
    s_cmp_eq_u32 s54, 0
    s_cbranch_scc1 L_nogpre
    s_bfe_u32 s59, s5, 0x20001
    s_lshl_b32 s59, s59, 7
    s_add_u32 s58, s80, s59
    v_and_b32 v13, 31, v1
    v_lshl_add_u32 v13, v13, 2, s58
    v_mov_b32 v18, 96096
    s_mov_b32 s11, 0
L_gkw:
    ds_read_b32 v16, v182 offset:12
    s_add_u32 s11, s11, 1
    s_waitcnt lgkmcnt(0)
    v_readfirstlane_b32 s58, v16
    s_nop 0
    s_cmp_ge_u32 s58, 4
    s_cbranch_scc1 L_gkw_done
    s_cmp_lt_u32 s11, 4000000
    s_cbranch_scc1 L_gkw
L_gkw_done:
    ds_read_b128 v[20:23], v18
    ds_read_b128 v[24:27], v18 offset:16
    s_waitcnt lgkmcnt(0)
    v_min_u32 v18, v20, v22
    v_max_u32 v16, v20, v22
    v_min_u32 v20, v24, v26
    v_max_u32 v22, v24, v26
    v_max3_u32 v17, v21, v23, v18
    v_max3_u32 v20, v25, v27, v20
    v_min_u32 v18, v16, v22
    v_max_u32 v16, v16, v22
    v_max3_u32 v17, v17, v20, v18
    v_readfirstlane_b32 s90, v16
    v_readfirstlane_b32 s91, v17
    s_andn2_b32 s52, 0x7ff, s90
    s_andn2_b32 s53, 0x7ff, s91
    v_mov_b32 v28, 0x7fffffff
    v_cmp_eq_u32 vcc, s52, v196
    v_cmp_eq_u32 s[58:59], s53, v196
    v_add_u32 v196, 8, v196
    s_or_b64 vcc, vcc, s[58:59]
    v_cndmask_b32 v192, v192, v28, vcc
    v_cmp_eq_u32 vcc, s52, v196
    v_cmp_eq_u32 s[58:59], s53, v196
    v_add_u32 v196, 8, v196
    s_or_b64 vcc, vcc, s[58:59]
    v_cndmask_b32 v193, v193, v28, vcc
    v_cmp_eq_u32 vcc, s52, v196
    v_cmp_eq_u32 s[58:59], s53, v196
    v_add_u32 v196, 8, v196
    s_or_b64 vcc, vcc, s[58:59]
    v_cndmask_b32 v194, v194, v28, vcc
    v_cmp_eq_u32 vcc, s52, v196
    v_cmp_eq_u32 s[58:59], s53, v196
    v_add_u32 v196, 8, v196
    s_or_b64 vcc, vcc, s[58:59]
    v_cndmask_b32 v195, v195, v28, vcc
L_nogpre:
    s_cmp_eq_u32 s61, 0
    s_cbranch_scc1 L_noep1
    ds_read_b32 v10, v116 offset:16
    ds_read_b128 v[16:19], v115 offset:5120
    ds_read_b128 v[20:23], v115 offset:15360
    ds_read_b128 v[24:27], v115 offset:25600
    ds_read_b128 v[28:31], v115 offset:35840
    s_waitcnt lgkmcnt(0)
    v_readfirstlane_b32 s58, v10
    s_nop 0
    s_cmp_ge_u32 s58, 4
    s_cbranch_scc1 L_e1_m
L_noep1:
    s_mov_b32 s11, 0
L_e1:
    ds_read_b32 v16, v116 offset:16
    s_add_u32 s11, s11, 1
    s_waitcnt lgkmcnt(0)
    v_readfirstlane_b32 s58, v16
    s_nop 0
    s_cmp_ge_u32 s58, 4
    s_cbranch_scc1 L_e1_done
    s_sleep 1
    s_cmp_lt_u32 s11, 4000000
    s_cbranch_scc1 L_e1
L_e1_done:
    ds_read_b128 v[16:19], v115 offset:5120
    ds_read_b128 v[20:23], v115 offset:15360
    ds_read_b128 v[24:27], v115 offset:25600
    ds_read_b128 v[28:31], v115 offset:35840
L_e1_m:
    s_cmp_lg_u32 s55, 0
    s_waitcnt lgkmcnt(2)
    v_fma_f32 v40, v16, v56, v40
    v_fma_f32 v41, v17, v57, v41
    v_fma_f32 v42, v18, v58, v42
    v_fma_f32 v43, v19, v59, v43
    v_fma_f32 v44, v20, v60, v44
    v_fma_f32 v45, v21, v61, v45
    v_fma_f32 v46, v22, v62, v46
    v_fma_f32 v47, v23, v63, v47
    s_waitcnt lgkmcnt(0)
    v_fma_f32 v16, v24, v56, v40
    v_fma_f32 v17, v25, v57, v41
    v_fma_f32 v18, v26, v58, v42
    v_fma_f32 v19, v27, v59, v43
    v_fma_f32 v20, v28, v60, v44
    v_fma_f32 v21, v29, v61, v45
    v_fma_f32 v22, v30, v62, v46
    v_fma_f32 v23, v31, v63, v47
    v_cvt_pk_bf16_f32 v92, v16, v20
    v_cvt_pk_bf16_f32 v93, v17, v21
    v_cvt_pk_bf16_f32 v94, v18, v22
    v_cvt_pk_bf16_f32 v95, v19, v23
    s_cbranch_scc1 L_e1_sp
    v_not_b32 v92, v92
    global_store_dwordx4 v113, v[92:95], s[44:45] offset:2048
L_e1_end:
    v_mov_b32 v10, 96148
    v_mov_b32 v11, 1
    s_mov_b64 exec, 1
    ds_add_u32 v10, v11
    s_mov_b64 exec, -1
    s_cmp_eq_u32 s54, 1
    s_cbranch_scc1 L_gather
    s_waitcnt vmcnt(0)
    s_mov_b64 exec, 1
    global_store_dword v96, v97, s[44:45]
    s_mov_b64 exec, -1
    s_branch L_fin
L_gather:
    global_load_dwordx4 v[32:35], v172, s[44:45] sc1
    global_load_dwordx4 v[36:39], v173, s[44:45] sc1
    global_load_dwordx4 v[40:43], v174, s[44:45] sc1
    global_load_dwordx4 v[44:47], v175, s[44:45] sc1
    global_load_dword v48, v13, s[44:45] sc1
    s_mov_b32 s11, 0
    s_mov_b32 s54, 0
    s_mov_b32 s11, 0
    s_waitcnt vmcnt(5)
    s_mov_b64 exec, 1
    global_store_dword v96, v97, s[44:45]
    s_mov_b64 exec, -1
    s_waitcnt vmcnt(1)
    s_branch L_gchk
L_gpoll:
    s_waitcnt vmcnt(0)
L_gchk:
    v_cmp_eq_u32 s[68:69], v32, v152
    v_cmp_eq_u32 s[70:71], v36, v156
    v_cmp_eq_u32 s[72:73], v40, v160
    v_cmp_eq_u32 s[74:75], v44, v164
    v_cmp_ne_u32 vcc, s7, v48
    s_or_b64 s[82:83], s[68:69], s[70:71]
    s_or_b64 s[58:59], s[72:73], s[74:75]
    s_or_b64 s[82:83], s[82:83], s[58:59]
    s_cbranch_scc0 L_gdone
    s_cmp_eq_u32 s54, 1
    s_cbranch_scc1 L_gdone
    s_add_u32 s11, s11, 1
    s_cmp_eq_u64 vcc, 0
    s_cselect_b32 s54, 1, 0
    s_cmp_gt_u32 s11, 100000
    s_cbranch_scc1 L_gdone
    s_or_b64 exec, s[68:69], 1
    global_load_dwordx4 v[32:35], v172, s[44:45] sc1
    s_or_b64 exec, s[70:71], 1
    global_load_dwordx4 v[36:39], v173, s[44:45] sc1
    s_or_b64 exec, s[72:73], 1
    global_load_dwordx4 v[40:43], v174, s[44:45] sc1
    s_or_b64 exec, s[74:75], 1
    global_load_dwordx4 v[44:47], v175, s[44:45] sc1
    s_mov_b64 exec, -1
    global_load_dword v48, v13, s[44:45] sc1
    s_branch L_gpoll
L_gdone:
    v_not_b32 v32, v32
    ds_write_b128 v197, v[32:35] offset:0
    v_not_b32 v36, v36
    ds_write_b128 v197, v[36:39] offset:1152
    v_not_b32 v40, v40
    ds_write_b128 v197, v[40:43] offset:2304
    v_not_b32 v44, v44
    ds_write_b128 v197, v[44:47] offset:3456
    ds_read_b32 v64, v198 offset:0
    ds_read_b32 v65, v198 offset:1152
    ds_read_b32 v66, v198 offset:2304
    ds_read_b32 v67, v198 offset:3456
    ds_read_b32 v68, v198 offset:32
    ds_read_b32 v69, v198 offset:1184
    ds_read_b32 v70, v198 offset:2336
    ds_read_b32 v71, v198 offset:3488
    ds_read_b32 v72, v198 offset:64
    ds_read_b32 v73, v198 offset:1216
    ds_read_b32 v74, v198 offset:2368
    ds_read_b32 v75, v198 offset:3520
    ds_read_b32 v76, v198 offset:96
    ds_read_b32 v77, v198 offset:1248
    ds_read_b32 v78, v198 offset:2400
    ds_read_b32 v79, v198 offset:3552
    s_waitcnt lgkmcnt(12)
    buffer_store_dwordx4 v[64:67], v192, s[48:51], 0 offen
    s_waitcnt lgkmcnt(8)
    buffer_store_dwordx4 v[68:71], v193, s[48:51], 0 offen
    s_waitcnt lgkmcnt(4)
    buffer_store_dwordx4 v[72:75], v194, s[48:51], 0 offen
    s_waitcnt lgkmcnt(0)
    buffer_store_dwordx4 v[76:79], v195, s[48:51], 0 offen
    s_branch L_fin
L_conv_head:
    global_load_dwordx4 v[248:251], v9, s[12:13]
    global_load_dwordx4 v[252:255], v9, s[12:13] offset:1024
    global_load_dwordx4 v[212:215], v9, s[12:13] offset:2048
    global_load_dwordx4 v[216:219], v9, s[12:13] offset:3072
    s_mov_b32 s62, 1.0
    s_cmp_eq_u32 s15, 0
    s_cselect_b32 s62, 0x43000000, s62
    s_cselect_b32 s63, 0x41800000, s63
    s_cselect_b32 s101, 0xbe22f983, s101
    v_mov_b32 v8, 0
    v_mov_b32 v9, 0
    v_lshrrev_b32 v32, 5, v1
    v_and_b32 v33, 31, v1
    s_cmp_lt_u32 s3, 2
    s_cbranch_scc0 L_z23
    s_lshl_b32 s58, s89, 1
    s_add_u32 s58, s58, s14
    s_lshl_b32 s58, s58, 13
    s_lshl_b32 s11, s4, 18
    s_add_u32 s11, s11, s58
    s_add_u32 s11, s11, 1048576
    v_lshl_add_u32 v2, v1, 7, s11
    s_mul_i32 s58, s14, 4608
    s_add_u32 s58, s58, 90176
    v_lshl_add_u32 v34, v1, 3, s58
    ds_write_b64 v34, v[8:9]
    v_mul_u32_u24 v35, 384, v32
    s_cmp_eq_u32 s14, 0
    s_cbranch_scc0 L_z1
    v_lshl_add_u32 v35, v33, 2, v35
    v_add_u32 v35, 95552, v35
    ds_write_b32 v35, v8
    s_branch L_zdone
L_z1:
    v_lshlrev_b32 v35, 2, v1
    v_add_u32 v35, 96064, v35
    ds_write_b32 v35, v8
    s_branch L_zdone
L_z23:
    s_lshl_b32 s11, s4, 8
    s_lshl_b32 s58, s14, 13
    s_add_u32 s11, s11, s58
    s_add_u32 s11, s11, 32768
    v_lshl_add_u32 v2, v32, 7, s11
    s_lshl_b32 s11, s4, 9
    s_add_u32 s11, s11, 36864
    v_and_b32 v35, 3, v1
    v_lshl_add_u32 v17, v35, 7, s11
    v_and_b32 v18, 4, v1
    v_cmp_ne_u32 vcc, 0, v18
    v_lshrrev_b32 v34, 2, v33
    v_mul_u32_u24 v34, 2320, v34
    v_cndmask_b32 v2, v2, v17, vcc
    v_mul_u32_u24 v35, 576, v35
    v_add_u32 v34, v34, v35
    v_add_u32 v34, 67520, v34
    ds_write_b64 v34, v[8:9]
    s_lshl_b32 s58, s14, 4
    v_lshl_add_u32 v36, v32, 3, v34
    v_add_u32 v36, s58, v36
    ds_write_b64 v36, v[8:9] offset:520
L_zdone:
    s_cmp_lt_u32 s5, 16
    s_cbranch_scc1 L_nopt0
    global_load_dword v238, v2, s[44:45]
L_nopt0:
    s_mul_i32 s68, s14, 9280
    s_add_u32 s68, s68, 67520
    s_lshl_b32 s59, s15, 4
    s_add_u32 s69, s68, s59
    s_lshl_b32 s59, s15, 7
    s_add_u32 s70, s68, s59
    s_add_u32 s70, s70, 264
    s_mul_i32 s71, s14, 33760
    s_mul_i32 s58, s14, 384
    s_add_u32 s11, s58, 95548
    v_lshlrev_b32 v227, 2, v1
    v_sub_u32 v231, s11, v227
    s_lshl_b32 s59, s15, 6
    s_add_u32 s72, s58, s59
    s_add_u32 s72, s72, 95296
    s_mul_i32 s58, s14, 4608
    s_add_u32 s73, s58, s59
    s_add_u32 s73, s73, 86080
    s_lshl_b32 s59, s15, 9
    s_sub_u32 s74, s58, s59
    s_add_u32 s74, s74, 88640
    s_mul_i32 s75, s3, 10240
    s_lshl_b32 s76, s15, 4
    s_lshl_b32 s58, s15, 8
    s_lshl_b32 s59, s14, 1
    s_add_u32 s58, s58, s59
    s_sub_u32 s58, 2047, s58
    v_sub_u32 v236, s58, v227
    v_subrev_u32 v234, 1, v236
    v_add_u32 v227, 96192, v227
    s_mov_b32 s11, 96064
    v_writelane_b32 v227, s11, 0
    v_mov_b32 v237, 1
    s_lshl_b32 s58, s3, 3
    s_add_u32 s58, s58, 96096
    v_mov_b32 v235, s58
    v_lshlrev_b32 v232, 4, v0
    v_add_u32 v232, 8200, v232
    v_add_u32 v233, 8192, v232
    v_mov_b32 v126, 96560
    v_mov_b32 v127, 96132
    s_waitcnt lgkmcnt(0)
    s_mov_b32 s48, s40
    s_and_b32 s49, s41, 0xffff
    s_mov_b32 s50, 0x200000
    s_mov_b32 s51, 0x20000
    s_lshl_b32 s11, s14, 4
    s_lshr_b32 s58, s8, s11
    s_lshl_b32 s58, s58, 16
    v_mov_b32 v61, 0x3fb8aa3b
    v_mul_f32 v60, s58, v61
    v_exp_f32 v60, v60
    s_nop 0
    v_cvt_pk_bf16_f32 v60, v60, v60
    v_and_b32 v60, s56, v60
    v_mul_f32 v57, 0xbfb8aa3b, v60
    v_mul_f32 v59, s101, v60
    v_mul_f32 v56, s62, v57
    v_mul_f32 v57, s63, v57
    v_mul_f32 v58, s62, v59
    v_mul_f32 v59, s63, v59
    v_add_f32 v60, v60, v60
    s_cmp_lt_u32 s5, 16
    s_cbranch_scc1 L_nopt
    s_waitcnt vmcnt(5)
    s_branch L_cprep
L_nopt:
    s_waitcnt vmcnt(4)
L_cprep:
    v_lshlrev_b32 v8, 16, v4
    v_and_b32 v9, s56, v4
    v_mul_f32 v8, v8, v61
    v_mul_f32 v9, v9, v61
    v_lshlrev_b32 v10, 16, v5
    v_and_b32 v11, s56, v5
    v_exp_f32 v8, v8
    v_exp_f32 v9, v9
    v_mul_f32 v30, v10, v58
    v_mul_f32 v31, v11, v58
    v_mul_f32 v38, v10, v59
    v_mul_f32 v39, v11, v59
    v_cvt_pk_bf16_f32 v9, v8, v9
    v_fract_f32 v30, v30
    v_fract_f32 v31, v31
    v_lshlrev_b32 v8, 16, v9
    v_and_b32 v9, s56, v9
    v_fract_f32 v38, v38
    v_fract_f32 v39, v39
    v_mul_f32 v28, v8, v56
    v_mul_f32 v29, v9, v56
    v_mul_f32 v36, v8, v57
    v_mul_f32 v37, v9, v57
    v_cos_f32 v16, v30
    v_sin_f32 v17, v30
    v_cos_f32 v18, v31
    v_sin_f32 v19, v31
    v_exp_f32 v28, v28
    v_exp_f32 v29, v29
    v_cos_f32 v20, v38
    v_sin_f32 v21, v38
    v_cos_f32 v22, v39
    v_sin_f32 v23, v39
    v_exp_f32 v36, v36
    v_exp_f32 v37, v37
    v_pk_mul_f32 v[16:17], v[16:17], v[28:29] op_sel_hi:[1,0]
    v_pk_mul_f32 v[18:19], v[18:19], v[28:29] op_sel:[0,1] op_sel_hi:[1,1]
    v_pk_mul_f32 v[20:21], v[20:21], v[36:37] op_sel_hi:[1,0]
    v_pk_mul_f32 v[22:23], v[22:23], v[36:37] op_sel:[0,1] op_sel_hi:[1,1]
    s_cmp_eq_u32 s15, 0
    s_cbranch_scc0 L_roleC
    v_mov_b32 v44, 0x3f80
    v_mov_b32 v45, 0x3f80
    ds_write_b64 v48, v[44:45]
    v_cvt_pk_bf16_f32 v46, v16, v17
    v_cvt_pk_bf16_f32 v47, v18, v19
    ds_write_b64 v48, v[46:47] offset:4352
    v_cvt_pk_bf16_f32 v44, v20, v21
    v_cvt_pk_bf16_f32 v45, v22, v23
    ds_write_b64 v48, v[44:45] offset:544
    v_pk_mul_f32 v[40:41], v[16:17], v[20:21] op_sel:[0,0] op_sel_hi:[1,0]
    v_pk_mul_f32 v[42:43], v[18:19], v[22:23] op_sel:[0,0] op_sel_hi:[1,0]
    v_pk_fma_f32 v[28:29], v[16:17], v[20:21], v[40:41] op_sel:[1,1,0] op_sel_hi:[0,1,1] neg_lo:[1,0,0]
    v_pk_fma_f32 v[30:31], v[18:19], v[22:23], v[42:43] op_sel:[1,1,0] op_sel_hi:[0,1,1] neg_lo:[1,0,0]
    v_pk_mul_f32 v[52:53], v[20:21], v[20:21] op_sel:[0,0] op_sel_hi:[1,0]
    v_pk_mul_f32 v[54:55], v[22:23], v[22:23] op_sel:[0,0] op_sel_hi:[1,0]
    v_pk_fma_f32 v[32:33], v[20:21], v[20:21], v[52:53] op_sel:[1,1,0] op_sel_hi:[0,1,1] neg_lo:[1,0,0]
    v_pk_fma_f32 v[34:35], v[22:23], v[22:23], v[54:55] op_sel:[1,1,0] op_sel_hi:[0,1,1] neg_lo:[1,0,0]
    v_cvt_pk_bf16_f32 v46, v28, v29
    v_cvt_pk_bf16_f32 v47, v30, v31
    ds_write_b64 v48, v[46:47] offset:4896
    v_pk_mul_f32 v[40:41], v[28:29], v[20:21] op_sel:[0,0] op_sel_hi:[1,0]
    v_pk_mul_f32 v[42:43], v[30:31], v[22:23] op_sel:[0,0] op_sel_hi:[1,0]
    v_pk_fma_f32 v[28:29], v[28:29], v[20:21], v[40:41] op_sel:[1,1,0] op_sel_hi:[0,1,1] neg_lo:[1,0,0]
    v_pk_fma_f32 v[30:31], v[30:31], v[22:23], v[42:43] op_sel:[1,1,0] op_sel_hi:[0,1,1] neg_lo:[1,0,0]
    v_cvt_pk_bf16_f32 v44, v32, v33
    v_cvt_pk_bf16_f32 v45, v34, v35
    ds_write_b64 v48, v[44:45] offset:1088
    v_pk_mul_f32 v[52:53], v[32:33], v[20:21] op_sel:[0,0] op_sel_hi:[1,0]
    v_pk_mul_f32 v[54:55], v[34:35], v[22:23] op_sel:[0,0] op_sel_hi:[1,0]
    v_pk_fma_f32 v[32:33], v[32:33], v[20:21], v[52:53] op_sel:[1,1,0] op_sel_hi:[0,1,1] neg_lo:[1,0,0]
    v_pk_fma_f32 v[34:35], v[34:35], v[22:23], v[54:55] op_sel:[1,1,0] op_sel_hi:[0,1,1] neg_lo:[1,0,0]
    v_cvt_pk_bf16_f32 v46, v28, v29
    v_cvt_pk_bf16_f32 v47, v30, v31
    ds_write_b64 v48, v[46:47] offset:5440
    v_pk_mul_f32 v[40:41], v[28:29], v[20:21] op_sel:[0,0] op_sel_hi:[1,0]
    v_pk_mul_f32 v[42:43], v[30:31], v[22:23] op_sel:[0,0] op_sel_hi:[1,0]
    v_pk_fma_f32 v[28:29], v[28:29], v[20:21], v[40:41] op_sel:[1,1,0] op_sel_hi:[0,1,1] neg_lo:[1,0,0]
    v_pk_fma_f32 v[30:31], v[30:31], v[22:23], v[42:43] op_sel:[1,1,0] op_sel_hi:[0,1,1] neg_lo:[1,0,0]
    v_cvt_pk_bf16_f32 v44, v32, v33
    v_cvt_pk_bf16_f32 v45, v34, v35
    ds_write_b64 v48, v[44:45] offset:1632
    v_pk_mul_f32 v[52:53], v[32:33], v[20:21] op_sel:[0,0] op_sel_hi:[1,0]
    v_pk_mul_f32 v[54:55], v[34:35], v[22:23] op_sel:[0,0] op_sel_hi:[1,0]
    v_pk_fma_f32 v[32:33], v[32:33], v[20:21], v[52:53] op_sel:[1,1,0] op_sel_hi:[0,1,1] neg_lo:[1,0,0]
    v_pk_fma_f32 v[34:35], v[34:35], v[22:23], v[54:55] op_sel:[1,1,0] op_sel_hi:[0,1,1] neg_lo:[1,0,0]
    v_cvt_pk_bf16_f32 v46, v28, v29
    v_cvt_pk_bf16_f32 v47, v30, v31
    ds_write_b64 v48, v[46:47] offset:5984
    v_pk_mul_f32 v[40:41], v[28:29], v[20:21] op_sel:[0,0] op_sel_hi:[1,0]
    v_pk_mul_f32 v[42:43], v[30:31], v[22:23] op_sel:[0,0] op_sel_hi:[1,0]
    v_pk_fma_f32 v[28:29], v[28:29], v[20:21], v[40:41] op_sel:[1,1,0] op_sel_hi:[0,1,1] neg_lo:[1,0,0]
    v_pk_fma_f32 v[30:31], v[30:31], v[22:23], v[42:43] op_sel:[1,1,0] op_sel_hi:[0,1,1] neg_lo:[1,0,0]
    v_cvt_pk_bf16_f32 v44, v32, v33
    v_cvt_pk_bf16_f32 v45, v34, v35
    ds_write_b64 v48, v[44:45] offset:2176
    v_pk_mul_f32 v[52:53], v[32:33], v[20:21] op_sel:[0,0] op_sel_hi:[1,0]
    v_pk_mul_f32 v[54:55], v[34:35], v[22:23] op_sel:[0,0] op_sel_hi:[1,0]
    v_pk_fma_f32 v[32:33], v[32:33], v[20:21], v[52:53] op_sel:[1,1,0] op_sel_hi:[0,1,1] neg_lo:[1,0,0]
    v_pk_fma_f32 v[34:35], v[34:35], v[22:23], v[54:55] op_sel:[1,1,0] op_sel_hi:[0,1,1] neg_lo:[1,0,0]
    v_cvt_pk_bf16_f32 v46, v28, v29
    v_cvt_pk_bf16_f32 v47, v30, v31
    ds_write_b64 v48, v[46:47] offset:6528
    v_pk_mul_f32 v[40:41], v[28:29], v[20:21] op_sel:[0,0] op_sel_hi:[1,0]
    v_pk_mul_f32 v[42:43], v[30:31], v[22:23] op_sel:[0,0] op_sel_hi:[1,0]
    v_pk_fma_f32 v[28:29], v[28:29], v[20:21], v[40:41] op_sel:[1,1,0] op_sel_hi:[0,1,1] neg_lo:[1,0,0]
    v_pk_fma_f32 v[30:31], v[30:31], v[22:23], v[42:43] op_sel:[1,1,0] op_sel_hi:[0,1,1] neg_lo:[1,0,0]
    v_cvt_pk_bf16_f32 v44, v32, v33
    v_cvt_pk_bf16_f32 v45, v34, v35
    ds_write_b64 v48, v[44:45] offset:2720
    v_pk_mul_f32 v[52:53], v[32:33], v[20:21] op_sel:[0,0] op_sel_hi:[1,0]
    v_pk_mul_f32 v[54:55], v[34:35], v[22:23] op_sel:[0,0] op_sel_hi:[1,0]
    v_pk_fma_f32 v[32:33], v[32:33], v[20:21], v[52:53] op_sel:[1,1,0] op_sel_hi:[0,1,1] neg_lo:[1,0,0]
    v_pk_fma_f32 v[34:35], v[34:35], v[22:23], v[54:55] op_sel:[1,1,0] op_sel_hi:[0,1,1] neg_lo:[1,0,0]
    v_cvt_pk_bf16_f32 v46, v28, v29
    v_cvt_pk_bf16_f32 v47, v30, v31
    ds_write_b64 v48, v[46:47] offset:7072
    v_pk_mul_f32 v[40:41], v[28:29], v[20:21] op_sel:[0,0] op_sel_hi:[1,0]
    v_pk_mul_f32 v[42:43], v[30:31], v[22:23] op_sel:[0,0] op_sel_hi:[1,0]
    v_pk_fma_f32 v[28:29], v[28:29], v[20:21], v[40:41] op_sel:[1,1,0] op_sel_hi:[0,1,1] neg_lo:[1,0,0]
    v_pk_fma_f32 v[30:31], v[30:31], v[22:23], v[42:43] op_sel:[1,1,0] op_sel_hi:[0,1,1] neg_lo:[1,0,0]
    v_cvt_pk_bf16_f32 v44, v32, v33
    v_cvt_pk_bf16_f32 v45, v34, v35
    ds_write_b64 v48, v[44:45] offset:3264
    v_pk_mul_f32 v[52:53], v[32:33], v[20:21] op_sel:[0,0] op_sel_hi:[1,0]
    v_pk_mul_f32 v[54:55], v[34:35], v[22:23] op_sel:[0,0] op_sel_hi:[1,0]
    v_pk_fma_f32 v[32:33], v[32:33], v[20:21], v[52:53] op_sel:[1,1,0] op_sel_hi:[0,1,1] neg_lo:[1,0,0]
    v_pk_fma_f32 v[34:35], v[34:35], v[22:23], v[54:55] op_sel:[1,1,0] op_sel_hi:[0,1,1] neg_lo:[1,0,0]
    v_cvt_pk_bf16_f32 v46, v28, v29
    v_cvt_pk_bf16_f32 v47, v30, v31
    ds_write_b64 v48, v[46:47] offset:7616
    v_pk_mul_f32 v[40:41], v[28:29], v[20:21] op_sel:[0,0] op_sel_hi:[1,0]
    v_pk_mul_f32 v[42:43], v[30:31], v[22:23] op_sel:[0,0] op_sel_hi:[1,0]
    v_pk_fma_f32 v[28:29], v[28:29], v[20:21], v[40:41] op_sel:[1,1,0] op_sel_hi:[0,1,1] neg_lo:[1,0,0]
    v_pk_fma_f32 v[30:31], v[30:31], v[22:23], v[42:43] op_sel:[1,1,0] op_sel_hi:[0,1,1] neg_lo:[1,0,0]
    v_cvt_pk_bf16_f32 v44, v32, v33
    v_cvt_pk_bf16_f32 v45, v34, v35
    ds_write_b64 v48, v[44:45] offset:3808
    v_cvt_pk_bf16_f32 v46, v28, v29
    v_cvt_pk_bf16_f32 v47, v30, v31
    ds_write_b64 v48, v[46:47] offset:8160
    s_branch L_conv
L_roleC:
    v_lshlrev_b32 v12, 16, v6
    v_lshlrev_b32 v13, 16, v7
    v_and_b32 v14, s56, v6
    v_and_b32 v15, s56, v7
    v_pk_mul_f32 v[12:13], v[12:13], v[60:61] op_sel_hi:[1,0]
    v_pk_mul_f32 v[14:15], v[14:15], v[60:61] op_sel_hi:[1,0]
    v_pk_mul_f32 v[40:41], v[16:17], v[16:17] op_sel:[0,0] op_sel_hi:[1,0]
    v_pk_mul_f32 v[42:43], v[18:19], v[18:19] op_sel:[0,0] op_sel_hi:[1,0]
    v_pk_fma_f32 v[24:25], v[16:17], v[16:17], v[40:41] op_sel:[1,1,0] op_sel_hi:[0,1,1] neg_lo:[1,0,0]
    v_pk_fma_f32 v[26:27], v[18:19], v[18:19], v[42:43] op_sel:[1,1,0] op_sel_hi:[0,1,1] neg_lo:[1,0,0]
    v_pk_mul_f32 v[52:53], v[12:13], v[16:17] op_sel:[0,0] op_sel_hi:[1,0]
    v_pk_mul_f32 v[54:55], v[14:15], v[18:19] op_sel:[0,0] op_sel_hi:[1,0]
    v_pk_fma_f32 v[28:29], v[12:13], v[16:17], v[52:53] op_sel:[1,1,0] op_sel_hi:[0,1,1] neg_lo:[1,0,0]
    v_pk_fma_f32 v[30:31], v[14:15], v[18:19], v[54:55] op_sel:[1,1,0] op_sel_hi:[0,1,1] neg_lo:[1,0,0]
    v_cvt_pk_bf16_f32 v44, v12, v13
    v_cvt_pk_bf16_f32 v45, v14, v15
    ds_write_b64 v48, v[44:45] offset:11424
    v_cvt_pk_bf16_f32 v46, v28, v29
    v_cvt_pk_bf16_f32 v47, v30, v31
    ds_write_b64 v48, v[46:47] offset:11968
    v_pk_mul_f32 v[52:53], v[28:29], v[16:17] op_sel:[0,0] op_sel_hi:[1,0]
    v_pk_mul_f32 v[54:55], v[30:31], v[18:19] op_sel:[0,0] op_sel_hi:[1,0]
    v_pk_fma_f32 v[32:33], v[28:29], v[16:17], v[52:53] op_sel:[1,1,0] op_sel_hi:[0,1,1] neg_lo:[1,0,0]
    v_pk_fma_f32 v[34:35], v[30:31], v[18:19], v[54:55] op_sel:[1,1,0] op_sel_hi:[0,1,1] neg_lo:[1,0,0]
    v_pk_mul_f32 v[40:41], v[28:29], v[24:25] op_sel:[0,0] op_sel_hi:[1,0]
    v_pk_mul_f32 v[42:43], v[30:31], v[26:27] op_sel:[0,0] op_sel_hi:[1,0]
    v_pk_fma_f32 v[28:29], v[28:29], v[24:25], v[40:41] op_sel:[1,1,0] op_sel_hi:[0,1,1] neg_lo:[1,0,0]
    v_pk_fma_f32 v[30:31], v[30:31], v[26:27], v[42:43] op_sel:[1,1,0] op_sel_hi:[0,1,1] neg_lo:[1,0,0]
    v_pk_mul_f32 v[52:53], v[32:33], v[20:21] op_sel:[0,0] op_sel_hi:[1,0]
    v_pk_mul_f32 v[54:55], v[34:35], v[22:23] op_sel:[0,0] op_sel_hi:[1,0]
    v_pk_fma_f32 v[36:37], v[32:33], v[20:21], v[52:53] op_sel:[1,1,0] op_sel_hi:[0,1,1] neg_lo:[1,0,0]
    v_pk_fma_f32 v[38:39], v[34:35], v[22:23], v[54:55] op_sel:[1,1,0] op_sel_hi:[0,1,1] neg_lo:[1,0,0]
    v_cvt_pk_bf16_f32 v44, v32, v33
    v_cvt_pk_bf16_f32 v45, v34, v35
    ds_write_b64 v48, v[44:45] offset:10880
    v_cvt_pk_bf16_f32 v46, v36, v37
    v_cvt_pk_bf16_f32 v47, v38, v39
    ds_write_b64 v48, v[46:47] offset:21216
    v_cvt_pk_bf16_f32 v44, v28, v29
    v_cvt_pk_bf16_f32 v45, v30, v31
    ds_write_b64 v48, v[44:45] offset:8704
    v_pk_mul_f32 v[40:41], v[28:29], v[24:25] op_sel:[0,0] op_sel_hi:[1,0]
    v_pk_mul_f32 v[42:43], v[30:31], v[26:27] op_sel:[0,0] op_sel_hi:[1,0]
    v_pk_fma_f32 v[28:29], v[28:29], v[24:25], v[40:41] op_sel:[1,1,0] op_sel_hi:[0,1,1] neg_lo:[1,0,0]
    v_pk_fma_f32 v[30:31], v[30:31], v[26:27], v[42:43] op_sel:[1,1,0] op_sel_hi:[0,1,1] neg_lo:[1,0,0]
    v_cvt_pk_bf16_f32 v46, v28, v29
    v_cvt_pk_bf16_f32 v47, v30, v31
    ds_write_b64 v48, v[46:47] offset:9792
    v_pk_mul_f32 v[52:53], v[28:29], v[16:17] op_sel:[0,0] op_sel_hi:[1,0]
    v_pk_mul_f32 v[54:55], v[30:31], v[18:19] op_sel:[0,0] op_sel_hi:[1,0]
    v_pk_fma_f32 v[32:33], v[28:29], v[16:17], v[52:53] op_sel:[1,1,0] op_sel_hi:[0,1,1] neg_lo:[1,0,0]
    v_pk_fma_f32 v[34:35], v[30:31], v[18:19], v[54:55] op_sel:[1,1,0] op_sel_hi:[0,1,1] neg_lo:[1,0,0]
    v_pk_mul_f32 v[40:41], v[28:29], v[24:25] op_sel:[0,0] op_sel_hi:[1,0]
    v_pk_mul_f32 v[42:43], v[30:31], v[26:27] op_sel:[0,0] op_sel_hi:[1,0]
    v_pk_fma_f32 v[28:29], v[28:29], v[24:25], v[40:41] op_sel:[1,1,0] op_sel_hi:[0,1,1] neg_lo:[1,0,0]
    v_pk_fma_f32 v[30:31], v[30:31], v[26:27], v[42:43] op_sel:[1,1,0] op_sel_hi:[0,1,1] neg_lo:[1,0,0]
    v_pk_mul_f32 v[52:53], v[32:33], v[20:21] op_sel:[0,0] op_sel_hi:[1,0]
    v_pk_mul_f32 v[54:55], v[34:35], v[22:23] op_sel:[0,0] op_sel_hi:[1,0]
    v_pk_fma_f32 v[36:37], v[32:33], v[20:21], v[52:53] op_sel:[1,1,0] op_sel_hi:[0,1,1] neg_lo:[1,0,0]
    v_pk_fma_f32 v[38:39], v[34:35], v[22:23], v[54:55] op_sel:[1,1,0] op_sel_hi:[0,1,1] neg_lo:[1,0,0]
    v_cvt_pk_bf16_f32 v44, v32, v33
    v_cvt_pk_bf16_f32 v45, v34, v35
    ds_write_b64 v48, v[44:45] offset:12512
    v_cvt_pk_bf16_f32 v46, v36, v37
    v_cvt_pk_bf16_f32 v47, v38, v39
    ds_write_b64 v48, v[46:47] offset:20672
    v_cvt_pk_bf16_f32 v44, v28, v29
    v_cvt_pk_bf16_f32 v45, v30, v31
    ds_write_b64 v48, v[44:45] offset:9248
    v_pk_mul_f32 v[40:41], v[28:29], v[24:25] op_sel:[0,0] op_sel_hi:[1,0]
    v_pk_mul_f32 v[42:43], v[30:31], v[26:27] op_sel:[0,0] op_sel_hi:[1,0]
    v_pk_fma_f32 v[28:29], v[28:29], v[24:25], v[40:41] op_sel:[1,1,0] op_sel_hi:[0,1,1] neg_lo:[1,0,0]
    v_pk_fma_f32 v[30:31], v[30:31], v[26:27], v[42:43] op_sel:[1,1,0] op_sel_hi:[0,1,1] neg_lo:[1,0,0]
    v_cvt_pk_bf16_f32 v46, v28, v29
    v_cvt_pk_bf16_f32 v47, v30, v31
    ds_write_b64 v48, v[46:47] offset:13056
    v_pk_mul_f32 v[52:53], v[28:29], v[16:17] op_sel:[0,0] op_sel_hi:[1,0]
    v_pk_mul_f32 v[54:55], v[30:31], v[18:19] op_sel:[0,0] op_sel_hi:[1,0]
    v_pk_fma_f32 v[32:33], v[28:29], v[16:17], v[52:53] op_sel:[1,1,0] op_sel_hi:[0,1,1] neg_lo:[1,0,0]
    v_pk_fma_f32 v[34:35], v[30:31], v[18:19], v[54:55] op_sel:[1,1,0] op_sel_hi:[0,1,1] neg_lo:[1,0,0]
    v_pk_mul_f32 v[40:41], v[28:29], v[24:25] op_sel:[0,0] op_sel_hi:[1,0]
    v_pk_mul_f32 v[42:43], v[30:31], v[26:27] op_sel:[0,0] op_sel_hi:[1,0]
    v_pk_fma_f32 v[28:29], v[28:29], v[24:25], v[40:41] op_sel:[1,1,0] op_sel_hi:[0,1,1] neg_lo:[1,0,0]
    v_pk_fma_f32 v[30:31], v[30:31], v[26:27], v[42:43] op_sel:[1,1,0] op_sel_hi:[0,1,1] neg_lo:[1,0,0]
    v_pk_mul_f32 v[52:53], v[32:33], v[20:21] op_sel:[0,0] op_sel_hi:[1,0]
    v_pk_mul_f32 v[54:55], v[34:35], v[22:23] op_sel:[0,0] op_sel_hi:[1,0]
    v_pk_fma_f32 v[36:37], v[32:33], v[20:21], v[52:53] op_sel:[1,1,0] op_sel_hi:[0,1,1] neg_lo:[1,0,0]
    v_pk_fma_f32 v[38:39], v[34:35], v[22:23], v[54:55] op_sel:[1,1,0] op_sel_hi:[0,1,1] neg_lo:[1,0,0]
    v_cvt_pk_bf16_f32 v44, v32, v33
    v_cvt_pk_bf16_f32 v45, v34, v35
    ds_write_b64 v48, v[44:45] offset:16320
    v_cvt_pk_bf16_f32 v46, v36, v37
    v_cvt_pk_bf16_f32 v47, v38, v39
    ds_write_b64 v48, v[46:47] offset:24480
    v_cvt_pk_bf16_f32 v44, v28, v29
    v_cvt_pk_bf16_f32 v45, v30, v31
    ds_write_b64 v48, v[44:45] offset:15776
    v_pk_mul_f32 v[40:41], v[28:29], v[24:25] op_sel:[0,0] op_sel_hi:[1,0]
    v_pk_mul_f32 v[42:43], v[30:31], v[26:27] op_sel:[0,0] op_sel_hi:[1,0]
    v_pk_fma_f32 v[28:29], v[28:29], v[24:25], v[40:41] op_sel:[1,1,0] op_sel_hi:[0,1,1] neg_lo:[1,0,0]
    v_pk_fma_f32 v[30:31], v[30:31], v[26:27], v[42:43] op_sel:[1,1,0] op_sel_hi:[0,1,1] neg_lo:[1,0,0]
    v_cvt_pk_bf16_f32 v46, v28, v29
    v_cvt_pk_bf16_f32 v47, v30, v31
    ds_write_b64 v48, v[46:47] offset:14688
    v_pk_mul_f32 v[52:53], v[28:29], v[16:17] op_sel:[0,0] op_sel_hi:[1,0]
    v_pk_mul_f32 v[54:55], v[30:31], v[18:19] op_sel:[0,0] op_sel_hi:[1,0]
    v_pk_fma_f32 v[32:33], v[28:29], v[16:17], v[52:53] op_sel:[1,1,0] op_sel_hi:[0,1,1] neg_lo:[1,0,0]
    v_pk_fma_f32 v[34:35], v[30:31], v[18:19], v[54:55] op_sel:[1,1,0] op_sel_hi:[0,1,1] neg_lo:[1,0,0]
    v_pk_mul_f32 v[40:41], v[28:29], v[24:25] op_sel:[0,0] op_sel_hi:[1,0]
    v_pk_mul_f32 v[42:43], v[30:31], v[26:27] op_sel:[0,0] op_sel_hi:[1,0]
    v_pk_fma_f32 v[28:29], v[28:29], v[24:25], v[40:41] op_sel:[1,1,0] op_sel_hi:[0,1,1] neg_lo:[1,0,0]
    v_pk_fma_f32 v[30:31], v[30:31], v[26:27], v[42:43] op_sel:[1,1,0] op_sel_hi:[0,1,1] neg_lo:[1,0,0]
    v_pk_mul_f32 v[52:53], v[32:33], v[20:21] op_sel:[0,0] op_sel_hi:[1,0]
    v_pk_mul_f32 v[54:55], v[34:35], v[22:23] op_sel:[0,0] op_sel_hi:[1,0]
    v_pk_fma_f32 v[36:37], v[32:33], v[20:21], v[52:53] op_sel:[1,1,0] op_sel_hi:[0,1,1] neg_lo:[1,0,0]
    v_pk_fma_f32 v[38:39], v[34:35], v[22:23], v[54:55] op_sel:[1,1,0] op_sel_hi:[0,1,1] neg_lo:[1,0,0]
    v_cvt_pk_bf16_f32 v44, v32, v33
    v_cvt_pk_bf16_f32 v45, v34, v35
    ds_write_b64 v48, v[44:45] offset:16864
    v_cvt_pk_bf16_f32 v46, v36, v37
    v_cvt_pk_bf16_f32 v47, v38, v39
    ds_write_b64 v48, v[46:47] offset:25024
    v_cvt_pk_bf16_f32 v44, v28, v29
    v_cvt_pk_bf16_f32 v45, v30, v31
    ds_write_b64 v48, v[44:45] offset:14144
L_conv:
    s_cmp_lt_u32 s5, 16
    s_cbranch_scc0 L_cw1
    s_waitcnt vmcnt(0)
L_cw1:
    s_waitcnt vmcnt(1)
    v_bfe_u32 v8, v250, s76, 16
    v_add_u32_sdwa v228, s71, v249 dst_sel:DWORD dst_unused:UNUSED_PAD src0_sel:DWORD src1_sel:WORD_0
    v_add_u32_sdwa v9, s71, v249 dst_sel:DWORD dst_unused:UNUSED_PAD src0_sel:DWORD src1_sel:WORD_1
    v_add_u32 v8, s71, v8
    s_waitcnt lgkmcnt(0)
    s_barrier
    ds_read_b32 v124, v126
    s_cmp_eq_u32 s61, 0
    s_cbranch_scc1 L_ce0
    global_load_dwordx2 v[240:241], v232, s[44:45] offset:-4096 sc1
    global_load_dwordx2 v[242:243], v232, s[44:45] sc1
    global_load_dwordx2 v[244:245], v233, s[44:45] offset:-4096 sc1
    global_load_dwordx2 v[246:247], v233, s[44:45] sc1
L_ce0:
    ds_read_b128 v[16:19], v228 offset:0
    ds_read_b128 v[20:23], v8 offset:0
    ds_read_b128 v[24:27], v9 offset:0
    ds_read_b128 v[28:31], v228 offset:64
    ds_read_b128 v[32:35], v8 offset:64
    ds_read_b128 v[36:39], v9 offset:64
    ds_read_b128 v[40:43], v228 offset:128
    ds_read_b128 v[44:47], v8 offset:128
    ds_read_b128 v[48:51], v9 offset:128
    ds_read_b128 v[52:55], v228 offset:192
    ds_read_b128 v[56:59], v8 offset:192
    ds_read_b128 v[60:63], v9 offset:192
    v_add_u32_sdwa v229, s70, v248 dst_sel:DWORD dst_unused:UNUSED_PAD src0_sel:DWORD src1_sel:WORD_0
    v_add_u32_sdwa v230, s70, v248 dst_sel:DWORD dst_unused:UNUSED_PAD src0_sel:DWORD src1_sel:WORD_1
    v_add_u32_sdwa v221, s69, v252 dst_sel:DWORD dst_unused:UNUSED_PAD src0_sel:DWORD src1_sel:WORD_0
    v_add_u32_sdwa v222, s69, v252 dst_sel:DWORD dst_unused:UNUSED_PAD src0_sel:DWORD src1_sel:WORD_1
    v_add_u32_sdwa v220, s68, v253 dst_sel:DWORD dst_unused:UNUSED_PAD src0_sel:DWORD src1_sel:WORD_0
    v_add_u32_sdwa v223, s72, v253 dst_sel:DWORD dst_unused:UNUSED_PAD src0_sel:DWORD src1_sel:WORD_1
    v_add_u32_sdwa v224, s73, v254 dst_sel:DWORD dst_unused:UNUSED_PAD src0_sel:DWORD src1_sel:WORD_0
    v_add_u32_sdwa v225, s74, v254 dst_sel:DWORD dst_unused:UNUSED_PAD src0_sel:DWORD src1_sel:WORD_0
    v_add_u32_sdwa v226, s75, v254 dst_sel:DWORD dst_unused:UNUSED_PAD src0_sel:DWORD src1_sel:WORD_1
    v_lshrrev_b32 v14, 4, v1
    v_and_b32 v15, 15, v1
    s_waitcnt lgkmcnt(9)
    v_mfma_f32_16x16x32_bf16 v[112:115], v[20:23], v[16:19], 0
    ds_read_b128 v[64:67], v228 offset:256
    ds_read_b128 v[68:71], v8 offset:256
    ds_read_b128 v[72:75], v9 offset:256
    v_mfma_f32_16x16x32_bf16 v[116:119], v[24:27], v[16:19], 0
    s_waitcnt lgkmcnt(9)
    v_mfma_f32_16x16x32_bf16 v[112:115], v[32:35], v[28:31], v[112:115]
    ds_read_b128 v[76:79], v228 offset:320
    ds_read_b128 v[80:83], v8 offset:320
    ds_read_b128 v[84:87], v9 offset:320
    v_mfma_f32_16x16x32_bf16 v[116:119], v[36:39], v[28:31], v[116:119]
    s_waitcnt lgkmcnt(9)
    v_mfma_f32_16x16x32_bf16 v[112:115], v[44:47], v[40:43], v[112:115]
    ds_read_b128 v[88:91], v228 offset:384
    ds_read_b128 v[92:95], v8 offset:384
    ds_read_b128 v[96:99], v9 offset:384
    v_mfma_f32_16x16x32_bf16 v[116:119], v[48:51], v[40:43], v[116:119]
    s_waitcnt lgkmcnt(9)
    v_mfma_f32_16x16x32_bf16 v[112:115], v[56:59], v[52:55], v[112:115]
    ds_read_b128 v[100:103], v228 offset:448
    ds_read_b128 v[104:107], v8 offset:448
    ds_read_b128 v[108:111], v9 offset:448
    v_mfma_f32_16x16x32_bf16 v[116:119], v[60:63], v[52:55], v[116:119]
    s_waitcnt lgkmcnt(9)
    v_mfma_f32_16x16x32_bf16 v[112:115], v[68:71], v[64:67], v[112:115]
    v_mfma_f32_16x16x32_bf16 v[116:119], v[72:75], v[64:67], v[116:119]
    s_waitcnt lgkmcnt(6)
    v_mfma_f32_16x16x32_bf16 v[112:115], v[80:83], v[76:79], v[112:115]
    v_mfma_f32_16x16x32_bf16 v[116:119], v[84:87], v[76:79], v[116:119]
    s_waitcnt lgkmcnt(3)
    v_mfma_f32_16x16x32_bf16 v[112:115], v[92:95], v[88:91], v[112:115]
    v_mfma_f32_16x16x32_bf16 v[116:119], v[96:99], v[88:91], v[116:119]
    s_waitcnt lgkmcnt(0)
    v_mfma_f32_16x16x32_bf16 v[112:115], v[104:107], v[100:103], v[112:115]
    v_mfma_f32_16x16x32_bf16 v[116:119], v[108:111], v[100:103], v[116:119]
    v_readfirstlane_b32 s46, v124
    v_mov_b32 v2, 96132
    s_andn2_b32 s7, s46, 15
    s_nop 3
    v_cvt_pk_bf16_f32 v16, v112, v113
    v_cvt_pk_bf16_f32 v17, v114, v115
    v_cvt_pk_bf16_f32 v18, v113, v114
    ds_write_b64 v229, v[16:17]
    ds_write_b32 v230, v16 offset:4644
    ds_write_b32 v229, v17 offset:4640
    ds_write_b16 v230, v16 offset:2326
    ds_write_b32 v229, v18 offset:2320
    ds_write_b16_d16_hi v229, v17 offset:2324
    ds_write_b16 v230, v16 offset:6962
    ds_write_b32 v230, v18 offset:6964
    ds_write_b16_d16_hi v229, v17 offset:6960
    v_cvt_pk_bf16_f32 v24, v118, v117
    ds_write_b32 v231, v24
    s_cmp_eq_u32 s15, 1
    s_cbranch_scc0 L_nospec
    v_readlane_b32 s58, v17, 63
    s_nop 1
    v_mov_b32 v25, s58
    ds_write_b16_d16_hi v220, v25
L_nospec:
    ds_add_u32 v227, v237 offset:68
    s_setprio 1
    s_cmp_eq_u32 s61, 0
    s_cbranch_scc1 L_t2skip
    s_mov_b32 s11, 0
L_cp0:
    s_waitcnt vmcnt(0)
    v_xor_b32 v34, s7, v241
    v_xor_b32 v35, s7, v243
    v_xor_b32 v36, s7, v245
    v_xor_b32 v37, s7, v247
    v_or_b32 v34, v34, v35
    v_or3_b32 v34, v34, v36, v37
    v_cmp_lt_u32 vcc, 15, v34
    s_add_u32 s11, s11, 1
    s_cmp_gt_u32 s11, 100000
    s_cbranch_scc1 L_cpd0
    s_cbranch_vccz L_cpd0
    global_load_dwordx2 v[240:241], v232, s[44:45] offset:-4096 sc1
    global_load_dwordx2 v[242:243], v232, s[44:45] sc1
    global_load_dwordx2 v[244:245], v233, s[44:45] offset:-4096 sc1
    global_load_dwordx2 v[246:247], v233, s[44:45] sc1
    s_branch L_cp0
L_cpd0:
    v_lshl_or_b32 v36, v240, 16, v236
    v_and_or_b32 v37, v240, s56, v234
    v_lshl_or_b32 v38, v242, 16, v236
    v_and_or_b32 v39, v242, s56, v234
    v_subrev_u32 v38, 512, v38
    v_subrev_u32 v39, 512, v39
    v_lshl_or_b32 v40, v244, 16, v236
    v_and_or_b32 v41, v244, s56, v234
    v_subrev_u32 v40, 1024, v40
    v_subrev_u32 v41, 1024, v41
    v_lshl_or_b32 v42, v246, 16, v236
    v_and_or_b32 v43, v246, s56, v234
    v_subrev_u32 v42, 1536, v42
    v_subrev_u32 v43, 1536, v43
    v_min_u32 v50, v36, v37
    v_max_u32 v36, v36, v37
    v_min_u32 v51, v38, v39
    v_max_u32 v38, v38, v39
    v_min_u32 v52, v40, v41
    v_max_u32 v40, v40, v41
    v_min_u32 v53, v42, v43
    v_max_u32 v42, v42, v43
    v_min_u32 v37, v36, v38
    v_max_u32 v36, v36, v38
    v_min_u32 v41, v40, v42
    v_max_u32 v40, v40, v42
    v_max3_u32 v37, v37, v50, v51
    v_max3_u32 v41, v41, v52, v53
    v_min_u32 v48, v36, v40
    v_max_u32 v44, v36, v40
    v_max3_u32 v45, v37, v41, v48
    s_nop 0
    v_min_u32_dpp v48, v44, v44 row_ror:8 row_mask:0xf bank_mask:0xf
    v_max_u32_dpp v47, v45, v45 row_ror:8 row_mask:0xf bank_mask:0xf
    v_max_u32_dpp v44, v44, v44 row_ror:8 row_mask:0xf bank_mask:0xf
    v_max_u32 v45, v47, v48
    s_nop 0
    v_min_u32_dpp v48, v44, v44 row_ror:4 row_mask:0xf bank_mask:0xf
    v_max_u32_dpp v47, v45, v45 row_ror:4 row_mask:0xf bank_mask:0xf
    v_max_u32_dpp v44, v44, v44 row_ror:4 row_mask:0xf bank_mask:0xf
    v_max_u32 v45, v47, v48
    s_nop 0
    v_min_u32_dpp v48, v44, v44 row_ror:2 row_mask:0xf bank_mask:0xf
    v_max_u32_dpp v47, v45, v45 row_ror:2 row_mask:0xf bank_mask:0xf
    v_max_u32_dpp v44, v44, v44 row_ror:2 row_mask:0xf bank_mask:0xf
    v_max_u32 v45, v47, v48
    s_nop 0
    v_min_u32_dpp v48, v44, v44 row_ror:1 row_mask:0xf bank_mask:0xf
    v_max_u32_dpp v47, v45, v45 row_ror:1 row_mask:0xf bank_mask:0xf
    v_max_u32_dpp v44, v44, v44 row_ror:1 row_mask:0xf bank_mask:0xf
    v_max_u32 v45, v47, v48
    v_mov_b32 v46, v44
    v_mov_b32 v47, v45
    s_nop 0
    v_permlane16_swap_b32 v44, v46
    v_permlane16_swap_b32 v45, v47
    v_min_u32 v48, v44, v46
    v_max_u32 v44, v44, v46
    v_max3_u32 v45, v45, v47, v48
    v_mov_b32 v46, v44
    v_mov_b32 v47, v45
    s_nop 0
    v_permlane32_swap_b32 v44, v46
    v_permlane32_swap_b32 v45, v47
    v_min_u32 v48, v44, v46
    v_max_u32 v44, v44, v46
    v_max3_u32 v45, v45, v47, v48
    s_mov_b64 exec, 1
    ds_write_b64 v235, v[44:45]
    ds_add_u32 v2, v237 offset:12
    s_mov_b64 exec, -1
    s_mov_b64 exec, 0xff00
    v_mov_b32 v44, v45
    s_mov_b64 exec, 0xffff
    v_and_b32 v44, 0x7ff, v44
    v_sub_u32 v44, 2047, v44
    v_and_b32 v46, 7, v1
    v_lshlrev_b32 v46, 7, v46
    v_lshl_add_u32 v44, v44, 10, v46
    global_load_dword v238, v44, s[16:17]
    s_mov_b64 exec, -1
L_t2skip:
    s_mov_b32 s11, 0
L_kw:
    ds_read_b32 v35, v127 offset:0
    s_add_u32 s11, s11, 1
    s_waitcnt lgkmcnt(0)
    v_readfirstlane_b32 s58, v35
    s_nop 0
    s_cmp_ge_u32 s58, 8
    s_cbranch_scc1 L_kw_done
    s_cmp_lt_u32 s11, 4000000
    s_cbranch_scc1 L_kw
L_kw_done:
    ds_read_b64 v[128:129], v221 offset:0
    ds_read_b64 v[130:131], v222 offset:0
    ds_read_b64 v[132:133], v221 offset:32
    ds_read_b64 v[134:135], v222 offset:32
    ds_read_b64 v[136:137], v221 offset:64
    ds_read_b64 v[138:139], v222 offset:64
    ds_read_b64 v[140:141], v221 offset:96
    ds_read_b64 v[142:143], v222 offset:96
    ds_read_b64 v[144:145], v221 offset:128
    ds_read_b64 v[146:147], v222 offset:128
    ds_read_b64 v[148:149], v221 offset:160
    ds_read_b64 v[150:151], v222 offset:160
    ds_read_b64 v[152:153], v221 offset:192
    ds_read_b64 v[154:155], v222 offset:192
    ds_read_b64 v[156:157], v221 offset:224
    ds_read_b64 v[158:159], v222 offset:224
    ds_read_b64 v[160:161], v221 offset:256
    ds_read_b64 v[162:163], v222 offset:256
    ds_read_b64 v[164:165], v221 offset:288
    ds_read_b64 v[166:167], v222 offset:288
    ds_read_b64 v[168:169], v221 offset:320
    ds_read_b64 v[170:171], v222 offset:320
    ds_read_b64 v[172:173], v221 offset:352
    ds_read_b64 v[174:175], v222 offset:352
    ds_read_b64 v[176:177], v221 offset:384
    ds_read_b64 v[178:179], v222 offset:384
    ds_read_b64 v[180:181], v221 offset:416
    ds_read_b64 v[182:183], v222 offset:416
    ds_read_b64 v[184:185], v221 offset:448
    ds_read_b64 v[186:187], v222 offset:448
    ds_read_b64 v[188:189], v221 offset:480
    ds_read_b64 v[190:191], v222 offset:480
    ds_read_b64 v[192:193], v221 offset:512
    ds_read_b64 v[194:195], v222 offset:512
    ds_read2_b32 v[196:197], v223 offset0:48 offset1:49
    ds_read2_b32 v[198:199], v223 offset0:50 offset1:51
    ds_read2_b32 v[200:201], v223 offset0:32 offset1:33
    ds_read2_b32 v[202:203], v223 offset0:34 offset1:35
    ds_read2_b32 v[204:205], v223 offset0:16 offset1:17
    ds_read2_b32 v[206:207], v223 offset0:18 offset1:19
    ds_read2_b32 v[208:209], v223 offset0:0 offset1:1
    ds_read2_b32 v[210:211], v223 offset0:2 offset1:3
    s_setprio 0
    s_mov_b32 s11, 0
L_uw:
    ds_read_b32 v35, v127 offset:8
    s_add_u32 s11, s11, 1
    s_waitcnt lgkmcnt(0)
    v_readfirstlane_b32 s58, v35
    s_nop 0
    s_cmp_ge_u32 s58, 4
    s_cbranch_scc1 L_uw_done
    s_sleep 1
    s_cmp_lt_u32 s11, 4000000
    s_cbranch_scc1 L_uw
L_uw_done:
    ds_read_b128 v[32:35], v224 offset:3968
    ds_read_b128 v[36:39], v224 offset:3840
    ds_read_b128 v[40:43], v224 offset:3712
    ds_read_b128 v[44:47], v224 offset:3584
    s_waitcnt lgkmcnt(3)
    v_mfma_f32_16x16x32_bf16 v[96:99], v[140:143], v[32:35], 0
    ds_read_b128 v[48:51], v224 offset:3456
    v_mfma_f32_16x16x32_bf16 v[100:103], v[156:159], v[32:35], 0
    ds_read_b128 v[52:55], v224 offset:3328
    v_mfma_f32_16x16x32_bf16 v[104:107], v[172:175], v[32:35], 0
    v_mfma_f32_16x16x32_bf16 v[108:111], v[188:191], v[32:35], 0
    s_waitcnt lgkmcnt(4)
    v_mfma_f32_16x16x32_bf16 v[96:99], v[136:139], v[36:39], v[96:99]
    ds_read_b128 v[56:59], v224 offset:3200
    v_mfma_f32_16x16x32_bf16 v[100:103], v[152:155], v[36:39], v[100:103]
    ds_read_b128 v[60:63], v224 offset:3072
    v_mfma_f32_16x16x32_bf16 v[104:107], v[168:171], v[36:39], v[104:107]
    v_mfma_f32_16x16x32_bf16 v[108:111], v[184:187], v[36:39], v[108:111]
    s_waitcnt lgkmcnt(5)
    v_mfma_f32_16x16x32_bf16 v[96:99], v[132:135], v[40:43], v[96:99]
    ds_read_b128 v[32:35], v224 offset:2944
    v_mfma_f32_16x16x32_bf16 v[100:103], v[148:151], v[40:43], v[100:103]
    ds_read_b128 v[16:19], v225 offset:1040
    ds_read_b128 v[20:23], v225 offset:1024
    v_mfma_f32_16x16x32_bf16 v[104:107], v[164:167], v[40:43], v[104:107]
    ds_read_b128 v[24:27], v225 offset:16
    ds_read_b128 v[28:31], v225 offset:0
    v_mfma_f32_16x16x32_bf16 v[108:111], v[180:183], v[40:43], v[108:111]
    s_waitcnt lgkmcnt(9)
    v_mfma_f32_16x16x32_bf16 v[96:99], v[128:131], v[44:47], v[96:99]
    ds_read_b128 v[36:39], v224 offset:2816
    v_mfma_f32_16x16x32_bf16 v[100:103], v[144:147], v[44:47], v[100:103]
    v_mfma_f32_16x16x32_bf16 v[104:107], v[160:163], v[44:47], v[104:107]
    v_mfma_f32_16x16x32_bf16 v[108:111], v[176:179], v[44:47], v[108:111]
    v_mfma_f32_16x16x32_bf16 v[112:115], v[192:195], v[44:47], 0
    s_waitcnt lgkmcnt(9)
    v_mfma_f32_16x16x32_bf16 v[100:103], v[140:143], v[48:51], v[100:103]
    ds_read_b128 v[40:43], v224 offset:2688
    ds_write_b128 v226, v[96:99] offset:0
    ds_add_u32 v227, v237 offset:0
    v_mfma_f32_16x16x32_bf16 v[104:107], v[156:159], v[48:51], v[104:107]
    v_mfma_f32_16x16x32_bf16 v[108:111], v[172:175], v[48:51], v[108:111]
    v_mfma_f32_16x16x32_bf16 v[112:115], v[188:191], v[48:51], v[112:115]
    s_waitcnt lgkmcnt(11)
    v_mfma_f32_16x16x32_bf16 v[100:103], v[136:139], v[52:55], v[100:103]
    ds_read_b128 v[44:47], v224 offset:2560
    v_mfma_f32_16x16x32_bf16 v[104:107], v[152:155], v[52:55], v[104:107]
    v_mfma_f32_16x16x32_bf16 v[108:111], v[168:171], v[52:55], v[108:111]
    v_mfma_f32_16x16x32_bf16 v[112:115], v[184:187], v[52:55], v[112:115]
    s_waitcnt lgkmcnt(5)
    v_mfma_f32_16x16x32_bf16 v[64:67], v[16:19], v[212:215], 0
    v_mfma_f32_16x16x32_bf16 v[68:71], v[20:23], v[216:219], 0
    v_mfma_f32_16x16x32_bf16 v[72:75], v[24:27], v[212:215], 0
    v_mfma_f32_16x16x32_bf16 v[76:79], v[28:31], v[216:219], 0
    v_mfma_f32_16x16x32_bf16 v[100:103], v[132:135], v[56:59], v[100:103]
    ds_read_b128 v[48:51], v224 offset:2432
    v_mfma_f32_16x16x32_bf16 v[104:107], v[148:151], v[56:59], v[104:107]
    v_mfma_f32_16x16x32_bf16 v[108:111], v[164:167], v[56:59], v[108:111]
    v_mfma_f32_16x16x32_bf16 v[112:115], v[180:183], v[56:59], v[112:115]
    v_mfma_f32_16x16x32_bf16 v[100:103], v[128:131], v[60:63], v[100:103]
    ds_read_b128 v[52:55], v224 offset:2304
    v_mfma_f32_16x16x32_bf16 v[104:107], v[144:147], v[60:63], v[104:107]
    v_mfma_f32_16x16x32_bf16 v[108:111], v[160:163], v[60:63], v[108:111]
    v_mfma_f32_16x16x32_bf16 v[112:115], v[176:179], v[60:63], v[112:115]
    v_mfma_f32_16x16x32_bf16 v[116:119], v[192:195], v[60:63], 0
    v_mfma_f32_16x16x32_bf16 v[104:107], v[140:143], v[32:35], v[104:107]
    ds_read_b128 v[56:59], v224 offset:2176
    s_nop 0
    ds_write_b128 v226, v[100:103] offset:1280
    ds_add_u32 v227, v237 offset:4
    v_mfma_f32_16x16x32_bf16 v[108:111], v[156:159], v[32:35], v[108:111]
    v_cvt_pk_bf16_f32 v80, v64, v68
    v_mfma_f32_16x16x32_bf16 v[112:115], v[172:175], v[32:35], v[112:115]
    v_cvt_pk_bf16_f32 v81, v65, v69
    v_mfma_f32_16x16x32_bf16 v[116:119], v[188:191], v[32:35], v[116:119]
    v_cvt_pk_bf16_f32 v82, v66, v70
    s_waitcnt lgkmcnt(9)
    v_mfma_f32_16x16x32_bf16 v[104:107], v[136:139], v[36:39], v[104:107]
    ds_read_b128 v[60:63], v224 offset:2048
    v_mfma_f32_16x16x32_bf16 v[108:111], v[152:155], v[36:39], v[108:111]
    v_cvt_pk_bf16_f32 v83, v67, v71
    v_mfma_f32_16x16x32_bf16 v[112:115], v[168:171], v[36:39], v[112:115]
    v_cvt_pk_bf16_f32 v84, v72, v76
    v_mfma_f32_16x16x32_bf16 v[116:119], v[184:187], v[36:39], v[116:119]
    v_cvt_pk_bf16_f32 v85, v73, v77
    s_waitcnt lgkmcnt(9)
    v_mfma_f32_16x16x32_bf16 v[104:107], v[132:135], v[40:43], v[104:107]
    ds_read_b128 v[32:35], v224 offset:1920
    v_mfma_f32_16x16x32_bf16 v[108:111], v[148:151], v[40:43], v[108:111]
    v_cvt_pk_bf16_f32 v86, v74, v78
    v_mfma_f32_16x16x32_bf16 v[112:115], v[164:167], v[40:43], v[112:115]
    v_cvt_pk_bf16_f32 v87, v75, v79
    v_mfma_f32_16x16x32_bf16 v[116:119], v[180:183], v[40:43], v[116:119]
    s_waitcnt lgkmcnt(7)
    v_mfma_f32_16x16x32_bf16 v[104:107], v[128:131], v[44:47], v[104:107]
    ds_read_b128 v[36:39], v224 offset:1792
    v_mfma_f32_16x16x32_bf16 v[108:111], v[144:147], v[44:47], v[108:111]
    v_mfma_f32_16x16x32_bf16 v[112:115], v[160:163], v[44:47], v[112:115]
    v_mfma_f32_16x16x32_bf16 v[116:119], v[176:179], v[44:47], v[116:119]
    v_mfma_f32_16x16x32_bf16 v[120:123], v[192:195], v[44:47], 0
    s_waitcnt lgkmcnt(7)
    v_mfma_f32_16x16x32_bf16 v[108:111], v[140:143], v[48:51], v[108:111]
    ds_read_b128 v[40:43], v224 offset:1664
    ds_write_b128 v226, v[104:107] offset:2560
    ds_add_u32 v227, v237 offset:8
    v_mfma_f32_16x16x32_bf16 v[112:115], v[156:159], v[48:51], v[112:115]
    v_mfma_f32_16x16x32_bf16 v[116:119], v[172:175], v[48:51], v[116:119]
    v_mfma_f32_16x16x32_bf16 v[120:123], v[188:191], v[48:51], v[120:123]
    s_waitcnt lgkmcnt(9)
    v_mfma_f32_16x16x32_bf16 v[108:111], v[136:139], v[52:55], v[108:111]
    ds_read_b128 v[44:47], v224 offset:1536
    v_mfma_f32_16x16x32_bf16 v[112:115], v[152:155], v[52:55], v[112:115]
    v_mfma_f32_16x16x32_bf16 v[116:119], v[168:171], v[52:55], v[116:119]
    v_mfma_f32_16x16x32_bf16 v[120:123], v[184:187], v[52:55], v[120:123]
    v_mfma_f32_16x16x32_bf16 v[112:115], v[80:83], v[196:199], v[112:115]
    v_mfma_f32_16x16x32_bf16 v[116:119], v[80:83], v[200:203], v[116:119]
    v_mfma_f32_16x16x32_bf16 v[120:123], v[80:83], v[204:207], v[120:123]
    v_mfma_f32_16x16x32_bf16 v[124:127], v[80:83], v[208:211], 0
    v_mfma_f32_16x16x32_bf16 v[120:123], v[84:87], v[196:199], v[120:123]
    v_mfma_f32_16x16x32_bf16 v[124:127], v[84:87], v[200:203], v[124:127]
    s_waitcnt lgkmcnt(9)
    v_mfma_f32_16x16x32_bf16 v[108:111], v[132:135], v[56:59], v[108:111]
    ds_read_b128 v[48:51], v224 offset:1408
    v_mfma_f32_16x16x32_bf16 v[112:115], v[148:151], v[56:59], v[112:115]
    v_mfma_f32_16x16x32_bf16 v[116:119], v[164:167], v[56:59], v[116:119]
    v_mfma_f32_16x16x32_bf16 v[120:123], v[180:183], v[56:59], v[120:123]
    s_waitcnt lgkmcnt(7)
    v_mfma_f32_16x16x32_bf16 v[108:111], v[128:131], v[60:63], v[108:111]
    ds_read_b128 v[52:55], v224 offset:1280
    v_mfma_f32_16x16x32_bf16 v[112:115], v[144:147], v[60:63], v[112:115]
    v_mfma_f32_16x16x32_bf16 v[116:119], v[160:163], v[60:63], v[116:119]
    v_mfma_f32_16x16x32_bf16 v[120:123], v[176:179], v[60:63], v[120:123]
    v_mfma_f32_16x16x32_bf16 v[124:127], v[192:195], v[60:63], v[124:127]
    s_waitcnt lgkmcnt(7)
    v_mfma_f32_16x16x32_bf16 v[112:115], v[140:143], v[32:35], v[112:115]
    ds_read_b128 v[56:59], v224 offset:1152
    ds_write_b128 v226, v[108:111] offset:3840
    ds_add_u32 v227, v237 offset:12
    v_mfma_f32_16x16x32_bf16 v[116:119], v[156:159], v[32:35], v[116:119]
    v_mfma_f32_16x16x32_bf16 v[120:123], v[172:175], v[32:35], v[120:123]
    v_mfma_f32_16x16x32_bf16 v[124:127], v[188:191], v[32:35], v[124:127]
    s_waitcnt lgkmcnt(9)
    v_mfma_f32_16x16x32_bf16 v[112:115], v[136:139], v[36:39], v[112:115]
    ds_read_b128 v[60:63], v224 offset:1024
    v_mfma_f32_16x16x32_bf16 v[116:119], v[152:155], v[36:39], v[116:119]
    v_mfma_f32_16x16x32_bf16 v[120:123], v[168:171], v[36:39], v[120:123]
    v_mfma_f32_16x16x32_bf16 v[124:127], v[184:187], v[36:39], v[124:127]
    s_waitcnt lgkmcnt(9)
    v_mfma_f32_16x16x32_bf16 v[112:115], v[132:135], v[40:43], v[112:115]
    ds_read_b128 v[32:35], v224 offset:896
    v_mfma_f32_16x16x32_bf16 v[116:119], v[148:151], v[40:43], v[116:119]
    v_mfma_f32_16x16x32_bf16 v[120:123], v[164:167], v[40:43], v[120:123]
    v_mfma_f32_16x16x32_bf16 v[124:127], v[180:183], v[40:43], v[124:127]
    s_waitcnt lgkmcnt(7)
    v_mfma_f32_16x16x32_bf16 v[112:115], v[128:131], v[44:47], v[112:115]
    ds_read_b128 v[36:39], v224 offset:768
    v_mfma_f32_16x16x32_bf16 v[116:119], v[144:147], v[44:47], v[116:119]
    v_mfma_f32_16x16x32_bf16 v[120:123], v[160:163], v[44:47], v[120:123]
    v_mfma_f32_16x16x32_bf16 v[124:127], v[176:179], v[44:47], v[124:127]
    s_waitcnt lgkmcnt(7)
    v_mfma_f32_16x16x32_bf16 v[116:119], v[140:143], v[48:51], v[116:119]
    ds_read_b128 v[40:43], v224 offset:640
    v_mfma_f32_16x16x32_bf16 v[120:123], v[156:159], v[48:51], v[120:123]
    ds_write_b128 v226, v[112:115] offset:5120
    ds_add_u32 v227, v237 offset:16
    v_mfma_f32_16x16x32_bf16 v[124:127], v[172:175], v[48:51], v[124:127]
    s_waitcnt lgkmcnt(9)
    v_mfma_f32_16x16x32_bf16 v[116:119], v[136:139], v[52:55], v[116:119]
    ds_read_b128 v[44:47], v224 offset:512
    v_mfma_f32_16x16x32_bf16 v[120:123], v[152:155], v[52:55], v[120:123]
    v_mfma_f32_16x16x32_bf16 v[124:127], v[168:171], v[52:55], v[124:127]
    s_waitcnt lgkmcnt(9)
    v_mfma_f32_16x16x32_bf16 v[116:119], v[132:135], v[56:59], v[116:119]
    ds_read_b128 v[48:51], v224 offset:384
    v_mfma_f32_16x16x32_bf16 v[120:123], v[148:151], v[56:59], v[120:123]
    v_mfma_f32_16x16x32_bf16 v[124:127], v[164:167], v[56:59], v[124:127]
    s_waitcnt lgkmcnt(7)
    v_mfma_f32_16x16x32_bf16 v[116:119], v[128:131], v[60:63], v[116:119]
    ds_read_b128 v[52:55], v224 offset:256
    v_mfma_f32_16x16x32_bf16 v[120:123], v[144:147], v[60:63], v[120:123]
    v_mfma_f32_16x16x32_bf16 v[124:127], v[160:163], v[60:63], v[124:127]
    s_waitcnt lgkmcnt(7)
    v_mfma_f32_16x16x32_bf16 v[120:123], v[140:143], v[32:35], v[120:123]
    ds_read_b128 v[56:59], v224 offset:128
    v_mfma_f32_16x16x32_bf16 v[124:127], v[156:159], v[32:35], v[124:127]
    s_waitcnt lgkmcnt(7)
    v_mfma_f32_16x16x32_bf16 v[120:123], v[136:139], v[36:39], v[120:123]
    ds_read_b128 v[60:63], v224 offset:0
    ds_write_b128 v226, v[116:119] offset:6400
    ds_add_u32 v227, v237 offset:20
    v_mfma_f32_16x16x32_bf16 v[124:127], v[152:155], v[36:39], v[124:127]
    s_waitcnt lgkmcnt(9)
    v_mfma_f32_16x16x32_bf16 v[120:123], v[132:135], v[40:43], v[120:123]
    v_mfma_f32_16x16x32_bf16 v[124:127], v[148:151], v[40:43], v[124:127]
    s_waitcnt lgkmcnt(6)
    v_mfma_f32_16x16x32_bf16 v[120:123], v[128:131], v[44:47], v[120:123]
    v_mfma_f32_16x16x32_bf16 v[124:127], v[144:147], v[44:47], v[124:127]
    s_waitcnt lgkmcnt(5)
    v_mfma_f32_16x16x32_bf16 v[124:127], v[140:143], v[48:51], v[124:127]
    s_waitcnt lgkmcnt(4)
    v_mfma_f32_16x16x32_bf16 v[124:127], v[136:139], v[52:55], v[124:127]
    s_waitcnt lgkmcnt(3)
    v_mfma_f32_16x16x32_bf16 v[124:127], v[132:135], v[56:59], v[124:127]
    s_waitcnt lgkmcnt(2)
    v_mfma_f32_16x16x32_bf16 v[124:127], v[128:131], v[60:63], v[124:127]
    ds_write_b128 v226, v[120:123] offset:7680
    ds_add_u32 v227, v237 offset:24
    s_nop 5
    ds_write_b128 v226, v[124:127] offset:8960
    ds_add_u32 v227, v237 offset:28
    s_cmp_gt_u32 s3, 1
    s_cbranch_scc1 L_fin
    v_lshlrev_b32 v59, 4, v1
    v_add_u32 v59, 67520, v59
    s_cmp_eq_u32 s3, 0
    s_cbranch_scc1 L_pollw
    v_mov_b32 v18, 96096
    s_mov_b32 s11, 0
L_kcf:
    ds_read_b32 v16, v2 offset:12
    s_add_u32 s11, s11, 1
    s_waitcnt lgkmcnt(0)
    v_readfirstlane_b32 s58, v16
    s_nop 0
    s_cmp_ge_u32 s58, 4
    s_cbranch_scc1 L_kcf_done
    s_cmp_lt_u32 s11, 4000000
    s_cbranch_scc1 L_kcf
L_kcf_done:
    ds_read_b128 v[20:23], v18
    ds_read_b128 v[24:27], v18 offset:16
    s_waitcnt lgkmcnt(0)
    v_min_u32 v18, v20, v22
    v_max_u32 v16, v20, v22
    v_min_u32 v20, v24, v26
    v_max_u32 v22, v24, v26
    v_max3_u32 v17, v21, v23, v18
    v_max3_u32 v20, v25, v27, v20
    v_min_u32 v18, v16, v22
    v_max_u32 v16, v16, v22
    v_max3_u32 v17, v17, v20, v18
    v_readfirstlane_b32 s90, v16
    v_readfirstlane_b32 s91, v17
    s_andn2_b32 s52, 0x7ff, s90
    s_andn2_b32 s53, 0x7ff, s91
    s_cmp_lg_u32 s2, 0
    s_cbranch_scc1 L_noep2
    v_mov_b32 v30, 0
    v_mov_b32 v31, s7
    s_mov_b64 exec, 1
    global_store_dword v30, v31, s[44:45]
    s_mov_b64 exec, -1
L_noep2:
    v_cmp_lt_u32 vcc, 31, v1
    v_and_b32 v19, 1, v14
    s_lshl_b32 s58, s6, 2
    v_cndmask_b32 v16, v16, v17, vcc
    v_and_b32 v17, 0x7ff, v16
    v_sub_u32 v17, 2047, v17
    v_lshl_add_u32 v18, v17, 10, s58
    v_lshl_add_u32 v18, v19, 1, v18
    global_load_ushort v20, v18, s[16:17]
    v_and_b32 v28, 0x700, v17
    v_and_b32 v29, 2, v17
    v_and_b32 v30, 0xfd, v17
    v_lshlrev_b32 v28, 3, v28
    v_lshl_add_u32 v28, v29, 9, v28
    v_lshl_add_u32 v28, v30, 2, v28
    v_add_u32 v28, 2048, v28
    global_load_dword v29, v28, s[44:45] offset:2048 sc1
    v_lshrrev_b32 v21, 8, v17
    v_mul_u32_u24 v21, 1280, v21
    v_bfe_u32 v22, v17, 2, 2
    v_mul_u32_u24 v22, 20, v22
    v_bfe_u32 v23, v17, 4, 4
    v_add_u32 v22, v22, v23
    v_lshl_add_u32 v21, v22, 4, v21
    v_and_b32 v22, 3, v17
    v_lshl_add_u32 v21, v22, 2, v21
    v_mul_u32_u24 v22, 10240, v19
    v_add_u32 v21, v21, v22
    v_sub_u32 v22, 2047, v17
    v_lshlrev_b32 v22, 1, v22
    v_mul_u32_u24 v23, 4608, v19
    v_add3_u32 v22, v22, v23, 0
    v_add_u32 v22, 86080, v22
    ds_read_u16 v24, v22
    v_mov_b32 v23, 96064
    s_mov_b32 s11, 0
L_fwait:
    ds_read_b32 v32, v23 offset:28
    s_add_u32 s11, s11, 1
    s_waitcnt lgkmcnt(0)
    v_readfirstlane_b32 s58, v32
    s_nop 0
    s_cmp_ge_u32 s58, 4
    s_cbranch_scc1 L_fwait_done
    s_cmp_lt_u32 s11, 4000000
    s_cbranch_scc1 L_fwait
L_fwait_done:
    ds_read_b32 v25, v21
    ds_read_b32 v26, v21 offset:20480
    v_ashrrev_i32 v27, 31, v16
    v_not_b32 v27, v27
    v_or_b32 v27, 0x80000000, v27
    v_xor_b32 v27, v16, v27
    v_and_b32 v27, s56, v27
    v_mul_f32 v27, 0xbfb8aa3b, v27
    v_exp_f32 v27, v27
    s_nop 0
    v_add_f32 v27, 1.0, v27
    v_rcp_f32 v27, v27
    s_nop 0
    v_cvt_pk_bf16_f32 v27, v27, v27
    v_and_b32 v27, s56, v27
    s_waitcnt lgkmcnt(0)
    v_lshlrev_b32 v24, 16, v24
    v_add_f32 v25, v25, v26
    v_lshlrev_b32 v31, 4, v19
    v_lshrrev_b32 v31, v31, s9
    v_lshlrev_b32 v31, 16, v31
    s_waitcnt vmcnt(0)
    v_and_b32 v30, s56, v29
    v_lshlrev_b32 v26, 16, v20
    v_rcp_f32 v30, v30
    v_lshlrev_b32 v29, 16, v29
    v_sub_f32 v29, v26, v29
    v_cvt_pk_bf16_f32 v29, v29, v29
    v_and_b32 v29, s56, v29
    v_mul_f32 v29, v29, v30
    v_cvt_pk_bf16_f32 v29, v29, v29
    v_and_b32 v29, s56, v29
    v_fma_f32 v25, -v24, v31, v25
    v_mul_f32 v30, v29, v31
    v_mov_b32 v24, v29
    v_cvt_pk_bf16_f32 v25, v25, v30
    v_and_b32 v30, s56, v25
    v_lshlrev_b32 v25, 16, v25
    v_add_f32 v25, v25, v30
    v_cvt_pk_bf16_f32 v25, v25, v25
    v_and_b32 v25, s56, v25
    ds_write_b128 v59, v[24:27]
    ds_write_b32 v59, v18 offset:1024
    s_mov_b64 exec, 1
    ds_add_u32 v2, v237 offset:20
    s_mov_b64 exec, -1
    s_branch L_fin
L_pollw:
    ds_read_b32 v19, v2 offset:4
    s_cmp_eq_u32 s4, 7
    s_cselect_b32 s59, 8, 10
    s_lshl_b32 s58, s4, 8
    s_add_u32 s58, s58, 40960
    v_min_u32 v60, s59, v15
    v_lshl_add_u32 v60, v60, 2, s58
    v_lshl_add_u32 v60, v14, 6, v60
    global_load_dword v61, v60, s[44:45] sc1
    s_lshl_b32 s58, s6, 4
    s_add_u32 s58, s58, 65536
    v_lshl_add_u32 v62, v1, 12, s58
    v_min_u32 v63, 21, v1
    v_add_u32 v63, 64, v63
    v_lshl_add_u32 v63, v63, 12, s58
    s_mov_b32 s80, 0x04000c0c
    s_mov_b32 s81, 0x0706000c
    s_mov_b32 s82, 0x00010001
    s_mov_b32 s83, 0x00010001
    s_mov_b32 s11, 0
    s_waitcnt lgkmcnt(0)
    v_readfirstlane_b32 s55, v19
    s_nop 0
    s_cmp_lg_u32 s55, 0
    s_cbranch_scc1 L_ofdone
L_ofpoll:
    s_waitcnt vmcnt(0)
    v_cmp_ne_u32 vcc, s7, v61
    s_add_u32 s11, s11, 1
    s_cmp_gt_u32 s11, 100000
    s_cbranch_scc1 L_ofdone
    s_cbranch_vccz L_ofdone
    global_load_dword v61, v60, s[44:45] sc1
    s_branch L_ofpoll
L_ofdone:
    s_mov_b32 s11, 0
L_ecw:
    ds_read_b32 v32, v2 offset:16
    s_add_u32 s11, s11, 1
    s_waitcnt lgkmcnt(0)
    v_readfirstlane_b32 s58, v32
    s_nop 0
    s_cmp_ge_u32 s58, 4
    s_cbranch_scc1 L_ecw_done
    s_cmp_lt_u32 s11, 4000000
    s_cbranch_scc1 L_ecw
L_ecw_done:
    global_load_dwordx4 v[64:67], v62, s[44:45] sc1
    global_load_dwordx4 v[68:71], v63, s[44:45] sc1
    s_mov_b32 s11, 0
L_pcw:
    ds_read_b32 v32, v2 offset:20
    s_add_u32 s11, s11, 1
    s_waitcnt lgkmcnt(0)
    v_readfirstlane_b32 s58, v32
    s_nop 0
    s_cmp_ge_u32 s58, 1
    s_cbranch_scc1 L_pcw_done
    s_cmp_lt_u32 s11, 4000000
    s_cbranch_scc1 L_pcw
L_pcw_done:
    ds_read_b128 v[24:27], v59
    ds_read_b32 v18, v59 offset:1024
    s_mov_b32 s11, 0
    s_branch L_pchk
L_ppoll:
    global_load_dwordx4 v[64:67], v62, s[44:45] sc1
    global_load_dwordx4 v[68:71], v63, s[44:45] sc1
L_pchk:
    s_add_u32 s11, s11, 1
    s_waitcnt vmcnt(0)
    v_xor_b32 v40, s7, v67
    v_xor_b32 v41, s7, v71
    v_or_b32 v40, v40, v41
    v_cmp_ne_u32 vcc, 0, v40
    v_perm_b32 v67, v64, v65, s80
    v_perm_b32 v71, v68, v69, s80
    s_cmp_gt_u32 s11, 100000
    s_cbranch_scc1 L_ppoll_done
    s_cbranch_vccz L_ppoll_done
    s_sleep 2
    s_branch L_ppoll
L_ppoll_done:
    v_perm_b32 v67, v67, v66, s81
    v_perm_b32 v71, v71, v70, s81
    s_mov_b64 exec, 0x3fffff
    v_add_f32 v64, v64, v68
    v_add_f32 v66, v66, v70
    v_add_f32 v65, v65, v69
    v_add_f32 v67, v67, v71
    s_mov_b64 exec, -1
    s_waitcnt lgkmcnt(0)
    v_permlane32_swap_b32 v64, v66
    v_permlane32_swap_b32 v65, v67
    v_add_f32 v64, v64, v66
    v_add_f32 v65, v65, v67
    s_nop 1
    v_permlane16_swap_b32 v64, v65
    v_add_f32 v40, v64, v65
    s_nop 1
    v_add_f32_dpp v40, v40, v40 row_ror:8 row_mask:0xf bank_mask:0xf
    s_nop 1
    v_add_f32_dpp v40, v40, v40 row_ror:4 row_mask:0xf bank_mask:0xf
    s_nop 1
    v_add_f32_dpp v40, v40, v40 row_ror:2 row_mask:0xf bank_mask:0xf
    s_nop 1
    v_add_f32_dpp v40, v40, v40 row_ror:1 row_mask:0xf bank_mask:0xf
    v_fma_f32 v40, v40, v27, v24
    v_mul_f32 v41, 0xbfb8aa3b, v40
    v_exp_f32 v41, v41
    v_mul_f32 v40, v40, v25
    v_add_f32 v41, 1.0, v41
    v_rcp_f32 v41, v41
    s_nop 0
    v_fma_f32 v40, v40, v41, v26
    v_cvt_pk_bf16_f32 v40, v40, v40
    s_mov_b64 exec, s[82:83]
    buffer_store_short v40, v18, s[48:51], 0 offen
    s_mov_b64 exec, -1
L_fin:
L_end:
    s_endpgm
L_e0_sp:
    v_mov_b32 v10, 96132
    v_mov_b32 v18, 96096
    s_mov_b32 s11, 0
L_e0_kw:
    ds_read_b32 v16, v10 offset:12
    s_add_u32 s11, s11, 1
    s_waitcnt lgkmcnt(0)
    v_readfirstlane_b32 s58, v16
    s_nop 0
    s_cmp_ge_u32 s58, 4
    s_cbranch_scc1 L_e0_kw_done
    s_sleep 1
    s_cmp_lt_u32 s11, 4000000
    s_cbranch_scc1 L_e0_kw
L_e0_kw_done:
    ds_read_b128 v[20:23], v18
    ds_read_b128 v[24:27], v18 offset:16
    s_waitcnt lgkmcnt(0)
    v_min_u32 v18, v20, v22
    v_max_u32 v16, v20, v22
    v_min_u32 v20, v24, v26
    v_max_u32 v22, v24, v26
    v_max3_u32 v17, v21, v23, v18
    v_max3_u32 v20, v25, v27, v20
    v_min_u32 v18, v16, v22
    v_max_u32 v16, v16, v22
    v_max3_u32 v17, v17, v20, v18
    v_readfirstlane_b32 s90, v16
    v_readfirstlane_b32 s91, v17
    s_andn2_b32 s52, 0x7ff, s90
    s_andn2_b32 s53, 0x7ff, s91
    s_add_u32 s11, s47, 0
    s_lshl_b32 s11, s11, 8
    v_lshl_add_u32 v28, v1, 2, s11
    v_add_u32 v30, 0, v124
    v_add_u32 v29, 0, v28
    v_cmp_ne_u32 vcc, s52, v29
    v_cmp_ne_u32 s[58:59], s53, v29
    s_nop 0
    s_and_b64 exec, vcc, s[58:59]
    buffer_store_dword v88, v30, s[48:51], 0 offen offset:0
    s_mov_b64 exec, -1
    v_add_u32 v29, 1, v28
    v_cmp_ne_u32 vcc, s52, v29
    v_cmp_ne_u32 s[58:59], s53, v29
    s_nop 0
    s_and_b64 exec, vcc, s[58:59]
    buffer_store_dword v89, v30, s[48:51], 0 offen offset:1024
    s_mov_b64 exec, -1
    v_add_u32 v29, 2, v28
    v_cmp_ne_u32 vcc, s52, v29
    v_cmp_ne_u32 s[58:59], s53, v29
    s_nop 0
    s_and_b64 exec, vcc, s[58:59]
    buffer_store_dword v90, v30, s[48:51], 0 offen offset:2048
    s_mov_b64 exec, -1
    v_add_u32 v29, 3, v28
    v_cmp_ne_u32 vcc, s52, v29
    v_cmp_ne_u32 s[58:59], s53, v29
    s_nop 0
    s_and_b64 exec, vcc, s[58:59]
    buffer_store_dword v91, v30, s[48:51], 0 offen offset:3072
    s_mov_b64 exec, -1
    s_branch L_e0_end
L_e1_sp:
    v_mov_b32 v10, 96132
    v_mov_b32 v18, 96096
    s_mov_b32 s11, 0
L_e1_kw:
    ds_read_b32 v16, v10 offset:12
    s_add_u32 s11, s11, 1
    s_waitcnt lgkmcnt(0)
    v_readfirstlane_b32 s58, v16
    s_nop 0
    s_cmp_ge_u32 s58, 4
    s_cbranch_scc1 L_e1_kw_done
    s_sleep 1
    s_cmp_lt_u32 s11, 4000000
    s_cbranch_scc1 L_e1_kw
L_e1_kw_done:
    ds_read_b128 v[20:23], v18
    ds_read_b128 v[24:27], v18 offset:16
    s_waitcnt lgkmcnt(0)
    v_min_u32 v18, v20, v22
    v_max_u32 v16, v20, v22
    v_min_u32 v20, v24, v26
    v_max_u32 v22, v24, v26
    v_max3_u32 v17, v21, v23, v18
    v_max3_u32 v20, v25, v27, v20
    v_min_u32 v18, v16, v22
    v_max_u32 v16, v16, v22
    v_max3_u32 v17, v17, v20, v18
    v_readfirstlane_b32 s90, v16
    v_readfirstlane_b32 s91, v17
    s_andn2_b32 s52, 0x7ff, s90
    s_andn2_b32 s53, 0x7ff, s91
    s_add_u32 s11, s47, 4
    s_lshl_b32 s11, s11, 8
    v_lshl_add_u32 v28, v1, 2, s11
    v_add_u32 v30, 1048576, v124
    v_add_u32 v29, 0, v28
    v_cmp_ne_u32 vcc, s52, v29
    v_cmp_ne_u32 s[58:59], s53, v29
    s_nop 0
    s_and_b64 exec, vcc, s[58:59]
    buffer_store_dword v92, v30, s[48:51], 0 offen offset:0
    s_mov_b64 exec, -1
    v_add_u32 v29, 1, v28
    v_cmp_ne_u32 vcc, s52, v29
    v_cmp_ne_u32 s[58:59], s53, v29
    s_nop 0
    s_and_b64 exec, vcc, s[58:59]
    buffer_store_dword v93, v30, s[48:51], 0 offen offset:1024
    s_mov_b64 exec, -1
    v_add_u32 v29, 2, v28
    v_cmp_ne_u32 vcc, s52, v29
    v_cmp_ne_u32 s[58:59], s53, v29
    s_nop 0
    s_and_b64 exec, vcc, s[58:59]
    buffer_store_dword v94, v30, s[48:51], 0 offen offset:2048
    s_mov_b64 exec, -1
    v_add_u32 v29, 3, v28
    v_cmp_ne_u32 vcc, s52, v29
    v_cmp_ne_u32 s[58:59], s53, v29
    s_nop 0
    s_and_b64 exec, vcc, s[58:59]
    buffer_store_dword v95, v30, s[48:51], 0 offen offset:3072
    s_mov_b64 exec, -1
    s_branch L_e1_end
L_xretry:
    s_waitcnt vmcnt(0)
    v_xor_b32 v234, s46, v234
    v_xor_b32 v235, s46, v235
    v_or_b32 v234, v234, v235
    v_cmp_ne_u32 vcc, 0, v234
    s_nop 0
    s_cbranch_vccz L_xs_ok
    s_lshr_b32 s58, s47, 1
    s_lshl_b32 s58, s58, 11
    s_and_b32 s59, s47, 1
    s_lshl_b32 s59, s59, 9
    s_add_u32 s58, s58, s59
    s_lshl_b32 s59, s4, 5
    s_add_u32 s58, s58, s59
    s_add_u32 s58, s58, 4108
    v_lshrrev_b32 v48, 5, v1
    v_lshl_add_u32 v48, v48, 8, s58
    v_add_u32 v49, 4096, v48
    s_mov_b32 s11, 0
L_xs1:
    global_load_dword v50, v48, s[44:45] sc1
    global_load_dword v51, v49, s[44:45] sc1
    global_load_dword v234, v112, s[44:45] sc1
    global_load_dword v235, v112, s[44:45] offset:128 sc1
    s_add_u32 s11, s11, 1
    s_waitcnt vmcnt(0)
    v_xor_b32 v234, s46, v234
    v_xor_b32 v235, s46, v235
    v_or_b32 v234, v234, v235
    v_cmp_ne_u32 vcc, 0, v234
    s_nop 0
    s_cbranch_vccz L_xs_ok
    v_xor_b32 v50, s46, v50
    v_xor_b32 v51, s46, v51
    v_subrev_u32 v50, 1, v50
    v_subrev_u32 v51, 1, v51
    v_min_u32 v50, v50, v51
    v_cmp_gt_u32 vcc, 15, v50
    s_cmp_gt_u32 s11, 100000
    s_cbranch_scc1 L_xdirect
    s_cbranch_vccz L_xs1
L_xdirect:
    v_add_u32 v48, 0x100000, v124
    global_load_dword v128, v124, s[16:17] offset:0
    global_load_dword v129, v124, s[16:17] offset:1024
    global_load_dword v130, v124, s[16:17] offset:2048
    global_load_dword v131, v124, s[16:17] offset:3072
    global_load_dword v132, v48, s[16:17] offset:0
    global_load_dword v133, v48, s[16:17] offset:1024
    global_load_dword v134, v48, s[16:17] offset:2048
    global_load_dword v135, v48, s[16:17] offset:3072
    s_branch L_gotx
L_xs_ok:
    global_load_dwordx4 v[128:131], v113, s[44:45] offset:-2048 sc1
    global_load_dwordx4 v[132:135], v113, s[44:45] offset:2048 sc1
    s_branch L_gotx
L_lnslow:
    v_lshlrev_b32 v32, 16, v16
    v_and_b32 v33, s56, v16
    v_lshlrev_b32 v34, 16, v17
    v_and_b32 v35, s56, v17
    v_lshlrev_b32 v36, 16, v18
    v_and_b32 v37, s56, v18
    v_lshlrev_b32 v38, 16, v19
    v_and_b32 v39, s56, v19
    v_lshlrev_b32 v40, 16, v20
    v_and_b32 v41, s56, v20
    v_lshlrev_b32 v42, 16, v21
    v_and_b32 v43, s56, v21
    v_lshlrev_b32 v44, 16, v22
    v_and_b32 v45, s56, v22
    v_lshlrev_b32 v46, 16, v23
    v_and_b32 v47, s56, v23
    v_mov_b32 v56, 0
    v_mov_b32 v57, 0
    v_pk_add_f32 v[58:59], v[32:33], v[52:53] op_sel_hi:[1,0] neg_lo:[0,1] neg_hi:[0,1]
    v_pk_add_f32 v[32:33], v[32:33], v[50:51] op_sel_hi:[1,0] neg_lo:[0,1] neg_hi:[0,1]
    v_cvt_pk_bf16_f32 v60, v58, v59
    v_pk_fma_f32 v[56:57], v[32:33], v[32:33], v[56:57]
    v_dot2_f32_bf16 v68, v60, v24, 0
    v_pk_add_f32 v[58:59], v[34:35], v[52:53] op_sel_hi:[1,0] neg_lo:[0,1] neg_hi:[0,1]
    v_pk_add_f32 v[34:35], v[34:35], v[50:51] op_sel_hi:[1,0] neg_lo:[0,1] neg_hi:[0,1]
    v_cvt_pk_bf16_f32 v61, v58, v59
    v_pk_fma_f32 v[56:57], v[34:35], v[34:35], v[56:57]
    v_dot2_f32_bf16 v68, v61, v25, v68
    v_pk_add_f32 v[58:59], v[36:37], v[52:53] op_sel_hi:[1,0] neg_lo:[0,1] neg_hi:[0,1]
    v_pk_add_f32 v[36:37], v[36:37], v[50:51] op_sel_hi:[1,0] neg_lo:[0,1] neg_hi:[0,1]
    v_cvt_pk_bf16_f32 v60, v58, v59
    v_pk_fma_f32 v[56:57], v[36:37], v[36:37], v[56:57]
    v_dot2_f32_bf16 v68, v60, v26, v68
    v_pk_add_f32 v[58:59], v[38:39], v[52:53] op_sel_hi:[1,0] neg_lo:[0,1] neg_hi:[0,1]
    v_pk_add_f32 v[38:39], v[38:39], v[50:51] op_sel_hi:[1,0] neg_lo:[0,1] neg_hi:[0,1]
    v_cvt_pk_bf16_f32 v61, v58, v59
    v_pk_fma_f32 v[56:57], v[38:39], v[38:39], v[56:57]
    v_dot2_f32_bf16 v68, v61, v27, v68
    v_pk_add_f32 v[58:59], v[40:41], v[52:53] op_sel_hi:[1,0] neg_lo:[0,1] neg_hi:[0,1]
    v_pk_add_f32 v[40:41], v[40:41], v[50:51] op_sel_hi:[1,0] neg_lo:[0,1] neg_hi:[0,1]
    v_cvt_pk_bf16_f32 v60, v58, v59
    v_pk_fma_f32 v[56:57], v[40:41], v[40:41], v[56:57]
    v_dot2_f32_bf16 v68, v60, v28, v68
    v_pk_add_f32 v[58:59], v[42:43], v[52:53] op_sel_hi:[1,0] neg_lo:[0,1] neg_hi:[0,1]
    v_pk_add_f32 v[42:43], v[42:43], v[50:51] op_sel_hi:[1,0] neg_lo:[0,1] neg_hi:[0,1]
    v_cvt_pk_bf16_f32 v61, v58, v59
    v_pk_fma_f32 v[56:57], v[42:43], v[42:43], v[56:57]
    v_dot2_f32_bf16 v68, v61, v29, v68
    v_pk_add_f32 v[58:59], v[44:45], v[52:53] op_sel_hi:[1,0] neg_lo:[0,1] neg_hi:[0,1]
    v_pk_add_f32 v[44:45], v[44:45], v[50:51] op_sel_hi:[1,0] neg_lo:[0,1] neg_hi:[0,1]
    v_cvt_pk_bf16_f32 v60, v58, v59
    v_pk_fma_f32 v[56:57], v[44:45], v[44:45], v[56:57]
    v_dot2_f32_bf16 v68, v60, v30, v68
    v_pk_add_f32 v[58:59], v[46:47], v[52:53] op_sel_hi:[1,0] neg_lo:[0,1] neg_hi:[0,1]
    v_pk_add_f32 v[46:47], v[46:47], v[50:51] op_sel_hi:[1,0] neg_lo:[0,1] neg_hi:[0,1]
    v_cvt_pk_bf16_f32 v61, v58, v59
    v_pk_fma_f32 v[56:57], v[46:47], v[46:47], v[56:57]
    v_dot2_f32_bf16 v68, v61, v31, v68
    v_add_f32 v56, v56, v57
    s_nop 1
    v_add_f32_dpp v56, v56, v56 row_ror:8 row_mask:0xf bank_mask:0xf
    v_add_f32_dpp v68, v68, v68 row_ror:8 row_mask:0xf bank_mask:0xf
    s_nop 0
    v_add_f32_dpp v56, v56, v56 row_ror:4 row_mask:0xf bank_mask:0xf
    v_add_f32_dpp v68, v68, v68 row_ror:4 row_mask:0xf bank_mask:0xf
    s_nop 0
    v_add_f32_dpp v56, v56, v56 row_ror:2 row_mask:0xf bank_mask:0xf
    v_add_f32_dpp v68, v68, v68 row_ror:2 row_mask:0xf bank_mask:0xf
    s_nop 0
    v_add_f32_dpp v56, v56, v56 row_ror:1 row_mask:0xf bank_mask:0xf
    v_add_f32_dpp v68, v68, v68 row_ror:1 row_mask:0xf bank_mask:0xf
    v_mov_b32 v57, v56
    v_mov_b32 v69, v68
    s_nop 0
    v_permlane16_swap_b32 v56, v57
    v_permlane16_swap_b32 v68, v69
    v_add_f32 v56, v56, v57
    v_add_f32 v68, v68, v69
    v_mul_f32 v56, 0x3b000000, v56
    v_cvt_pk_bf16_f32 v56, v56, v56
    s_branch L_lnjoin
.p2align 7
L_ctab:
.long 0x06b80000, 0x81a00000, 0x70a05720, 0x4ea02ca0, 0x06c00008, 0x81a00220, 0x70a05720, 0x4ea02ec0, 0x06c80010, 0x6a400440, 0x70a05720, 0x52e02a80, 0x06d00018, 0x6a400660, 0x63e05940, 0x48402200
.long 0x06d80020, 0x72c00880, 0x63e05940, 0x48402860, 0x06e00028, 0x72c00aa0, 0x63e05940, 0x48402640, 0x06e80030, 0x6c600cc0, 0x68204a60, 0x50c030e0, 0x06f00038, 0x6c600ee0, 0x68204a60, 0x4c802420
.long 0x06f80040, 0x66001100, 0x68204a60, 0x4c803b80, 0x07000048, 0x66001320, 0x68204a60, 0x4c803300, 0x07080050, 0x74e01540, 0x68204a60, 0x5fa03fc0, 0x07100058, 0x74e01760, 0x6e804400, 0x46203da0
.long 0x07180060, 0x7d601980, 0x6e804400, 0x46203520, 0x07200068, 0x7d601ba0, 0x6e804400, 0x46203960, 0x07280070, 0x7f801dc0, 0x55005b60, 0x61c041e0, 0x07300078, 0x7f801fe0, 0x55005b60, 0x5d803740
.long 0x00000240, 0x81b00010, 0x70b05730, 0x4eb02cb0, 0x00080248, 0x81b00230, 0x70b05730, 0x4eb02ed0, 0x00100250, 0x6a500450, 0x70b05730, 0x52f02a90, 0x00180258, 0x6a500670, 0x63f05950, 0x48502210
.long 0x00200260, 0x72d00890, 0x63f05950, 0x48502870, 0x00280268, 0x72d00ab0, 0x63f05950, 0x48502650, 0x00300270, 0x6c700cd0, 0x68304a70, 0x50d030f0, 0x00380278, 0x6c700ef0, 0x68304a70, 0x4c902430
.long 0x00400280, 0x66101110, 0x68304a70, 0x4c903b90, 0x00480288, 0x66101330, 0x68304a70, 0x4c903310, 0x00500290, 0x74f01550, 0x68304a70, 0x5fb03fd0, 0x00580298, 0x74f01770, 0x6e904410, 0x46303db0
.long 0x006002a0, 0x7d701990, 0x6e904410, 0x46303530, 0x006802a8, 0x7d701bb0, 0x6e904410, 0x46303970, 0x007002b0, 0x7f901dd0, 0x55105b70, 0x61d041f0, 0x007802b8, 0x7f901ff0, 0x55105b70, 0x5d903750
.long 0x02400480, 0x81c00020, 0x70c05740, 0x4ec02cc0, 0x02480488, 0x81c00240, 0x70c05740, 0x4ec02ee0, 0x02500490, 0x6a600460, 0x70c05740, 0x53002aa0, 0x02580498, 0x6a600680, 0x64005960, 0x48602220
.long 0x026004a0, 0x72e008a0, 0x64005960, 0x48602880, 0x026804a8, 0x72e00ac0, 0x64005960, 0x48602660, 0x027004b0, 0x6c800ce0, 0x68404a80, 0x50e03100, 0x027804b8, 0x6c800f00, 0x68404a80, 0x4ca02440
.long 0x028004c0, 0x66201120, 0x68404a80, 0x4ca03ba0, 0x028804c8, 0x66201340, 0x68404a80, 0x4ca03320, 0x029004d0, 0x75001560, 0x68404a80, 0x5fc03fe0, 0x029804d8, 0x75001780, 0x6ea04420, 0x46403dc0
.long 0x02a004e0, 0x7d8019a0, 0x6ea04420, 0x46403540, 0x02a804e8, 0x7d801bc0, 0x6ea04420, 0x46403980, 0x02b004f0, 0x7fa01de0, 0x55205b80, 0x61e04200, 0x02b804f8, 0x7fa02000, 0x55205b80, 0x5da03760
.long 0x048006c0, 0x81d00030, 0x70d05750, 0x4ed02cd0, 0x048806c8, 0x81d00250, 0x70d05750, 0x4ed02ef0, 0x049006d0, 0x6a700470, 0x70d05750, 0x53102ab0, 0x049806d8, 0x6a700690, 0x64105970, 0x48702230
.long 0x04a006e0, 0x72f008b0, 0x64105970, 0x48702890, 0x04a806e8, 0x72f00ad0, 0x64105970, 0x48702670, 0x04b006f0, 0x6c900cf0, 0x68504a90, 0x50f03110, 0x04b806f8, 0x6c900f10, 0x68504a90, 0x4cb02450
.long 0x04c00700, 0x66301130, 0x68504a90, 0x4cb03bb0, 0x04c80708, 0x66301350, 0x68504a90, 0x4cb03330, 0x04d00710, 0x75101570, 0x68504a90, 0x5fd03ff0, 0x04d80718, 0x75101790, 0x6eb04430, 0x46503dd0
.long 0x04e00720, 0x7d9019b0, 0x6eb04430, 0x46503550, 0x04e80728, 0x7d901bd0, 0x6eb04430, 0x46503990, 0x04f00730, 0x7fb01df0, 0x55305b90, 0x61f04210, 0x04f80738, 0x7fb02010, 0x55305b90, 0x5db03770
.long 0x0b500910, 0x003c0208, 0x000001e0, 0x00000000, 0x14601220, 0x003811d6, 0x001001c0, 0x00000000, 0x1d701b30, 0x00341ae4, 0x002001a0, 0x00000000, 0x04800240, 0x003023f2, 0x00300180, 0x00000000
.long 0x0d900b50, 0x002c020a, 0x00400160, 0x00000000, 0x16a01460, 0x00280b18, 0x00500140, 0x00000000, 0x1fb01d70, 0x00241ae6, 0x00600120, 0x00000000, 0x06c00480, 0x002023f4, 0x00700100, 0x00000000
.long 0x0fd00d90, 0x001c020c, 0x008000e0, 0x00000000, 0x18e016a0, 0x00180b1a, 0x009000c0, 0x00000000, 0x21f01fb0, 0x00141428, 0x00a000a0, 0x00000000, 0x000806c0, 0x001023f6, 0x00b00080, 0x00000000
.long 0x09180fd0, 0x000c020e, 0x00c00060, 0x00000000, 0x122818e0, 0x00080b1c, 0x00d00040, 0x00000000, 0x1b3821f0, 0x0004142a, 0x00e00020, 0x00000000, 0x02480008, 0x00001d38, 0x00f00000, 0x00000000
.long 0x0fd00d90, 0x004c0448, 0x014001f0, 0x00000000, 0x18e016a0, 0x00480b1e, 0x015001d0, 0x00000000, 0x21f01fb0, 0x0044142c, 0x016001b0, 0x00000000, 0x000806c0, 0x00401d3a, 0x01700190, 0x00000000
.long 0x09180fd0, 0x003c0448, 0x01800170, 0x00000000, 0x122818e0, 0x00380b1e, 0x01900150, 0x00000000, 0x1b3821f0, 0x0034142c, 0x01a00130, 0x00000000, 0x02480008, 0x00301d3a, 0x01b00110, 0x00000000
.long 0x0b580918, 0x002c0448, 0x01c000f0, 0x00000000, 0x14681228, 0x00280b1e, 0x01d000d0, 0x00000000, 0x1d781b38, 0x0024142c, 0x01e000b0, 0x00000000, 0x04880248, 0x00201d3a, 0x01f00090, 0x00000000
.long 0x0d980b58, 0x001c0448, 0x02000070, 0x00000000, 0x16a81468, 0x00180b1e, 0x02100050, 0x00000000, 0x1fb81d78, 0x0014142c, 0x02200030, 0x00000000, 0x06c80488, 0x00101d3a, 0x02300010, 0x00000000
.long 0x0b580918, 0x005c0448, 0x02800200, 0x00000000, 0x14681228, 0x00580b1e, 0x029001e0, 0x00000000, 0x1d781b38, 0x0054142c, 0x02a001c0, 0x00000000, 0x04880248, 0x00501d3a, 0x02b001a0, 0x00000000
.long 0x0d980b58, 0x004c0448, 0x02c00180, 0x00000000, 0x16a81468, 0x00480b1e, 0x02d00160, 0x00000000, 0x1fb81d78, 0x0044142c, 0x02e00140, 0x00000000, 0x06c80488, 0x00401d3a, 0x02f00120, 0x00000000
.long 0x0fd80d98, 0x003c0448, 0x03000100, 0x00000000, 0x18e816a8, 0x00380b1e, 0x031000e0, 0x00000000, 0x21f81fb8, 0x0034142c, 0x032000c0, 0x00000000, 0x001006c8, 0x00301d3a, 0x033000a0, 0x00000000
.long 0x09200fd8, 0x002c0448, 0x03400080, 0x00000000, 0x123018e8, 0x00280b1e, 0x03500060, 0x00000000, 0x1b4021f8, 0x0024142c, 0x03600040, 0x00000000, 0x02500010, 0x00201d3a, 0x03700020, 0x00000000
.long 0x0fd80d98, 0x006c0448, 0x03c00210, 0x00000000, 0x18e816a8, 0x00680b1e, 0x03d001f0, 0x00000000, 0x21f81fb8, 0x0064142c, 0x03e001d0, 0x00000000, 0x001006c8, 0x00601d3a, 0x03f001b0, 0x00000000
.long 0x09200fd8, 0x005c0448, 0x04000190, 0x00000000, 0x123018e8, 0x00580b1e, 0x04100170, 0x00000000, 0x1b4021f8, 0x0054142c, 0x04200150, 0x00000000, 0x02500010, 0x00501d3a, 0x04300130, 0x00000000
.long 0x0b600920, 0x004c0448, 0x04400110, 0x00000000, 0x14701230, 0x00480b1e, 0x045000f0, 0x00000000, 0x1d801b40, 0x0044142c, 0x046000d0, 0x00000000, 0x04900250, 0x00401d3a, 0x047000b0, 0x00000000
.long 0x0da00b60, 0x003c0448, 0x04800090, 0x00000000, 0x16b01470, 0x00380b1e, 0x04900070, 0x00000000, 0x1fc01d80, 0x0034142c, 0x04a00050, 0x00000000, 0x06d00490, 0x00301d3a, 0x04b00030, 0x00000000
.long 0x00000000, 0x00000000, 0x00000000, 0x00000000, 0x00000000, 0x00000000, 0x00000000, 0x00000000, 0x00000000, 0x00000000, 0x00000000, 0x00000000, 0x00000000, 0x00000000, 0x00000000, 0x00000000
.long 0x00000000, 0x00000000, 0x00000000, 0x00000000, 0x00000000, 0x00000000, 0x00000000, 0x00000000, 0x00000000, 0x00000000, 0x00000000, 0x00000000, 0x00000000, 0x00000000, 0x00000000, 0x00000000
.long 0x00000000, 0x00000000, 0x00000000, 0x00000000, 0x00000000, 0x00000000, 0x00000000, 0x00000000, 0x00000000, 0x00000000, 0x00000000, 0x00000000, 0x00000000, 0x00000000, 0x00000000, 0x00000000
.long 0x00000000, 0x00000000, 0x00000000, 0x3f800000, 0x00000000, 0x00000000, 0x00000000, 0x3f803f80, 0x00000000, 0x00000000, 0x3f800000, 0x3f803f80, 0x00000000, 0x00000000, 0x3f803f80, 0x3f803f80
.long 0x00000000, 0x00000000, 0x00000000, 0x00000000, 0x00000000, 0x00000000, 0x00000000, 0x00000000, 0x00000000, 0x00000000, 0x00000000, 0x00000000, 0x00000000, 0x00000000, 0x00000000, 0x00000000
.long 0x00000000, 0x00000000, 0x00000000, 0x3f800000, 0x00000000, 0x00000000, 0x00000000, 0x3f803f80, 0x00000000, 0x00000000, 0x3f800000, 0x3f803f80, 0x00000000, 0x00000000, 0x3f803f80, 0x3f803f80
.long 0x00000000, 0x3f800000, 0x3f803f80, 0x3f803f80, 0x00000000, 0x3f803f80, 0x3f803f80, 0x3f803f80, 0x3f800000, 0x3f803f80, 0x3f803f80, 0x3f803f80, 0x3f803f80, 0x3f803f80, 0x3f803f80, 0x3f803f80
.long 0x3f803f80, 0x3f803f80, 0x3f803f80, 0x3f803f80, 0x3f803f80, 0x3f803f80, 0x3f803f80, 0x00003f80, 0x3f803f80, 0x3f803f80, 0x3f803f80, 0x00000000, 0x3f803f80, 0x3f803f80, 0x00003f80, 0x00000000
.long 0x00000000, 0x3f800000, 0x3f803f80, 0x3f803f80, 0x00000000, 0x3f803f80, 0x3f803f80, 0x3f803f80, 0x3f800000, 0x3f803f80, 0x3f803f80, 0x3f803f80, 0x3f803f80, 0x3f803f80, 0x3f803f80, 0x3f803f80
.long 0x3f803f80, 0x3f803f80, 0x3f803f80, 0x3f803f80, 0x3f803f80, 0x3f803f80, 0x3f803f80, 0x00003f80, 0x3f803f80, 0x3f803f80, 0x3f803f80, 0x00000000, 0x3f803f80, 0x3f803f80, 0x00003f80, 0x00000000
.long 0x3f803f80, 0x3f803f80, 0x00000000, 0x00000000, 0x3f803f80, 0x00003f80, 0x00000000, 0x00000000, 0x3f803f80, 0x00000000, 0x00000000, 0x00000000, 0x00003f80, 0x00000000, 0x00000000, 0x00000000
.long 0x00000000, 0x00000000, 0x00000000, 0x00000000, 0x00000000, 0x00000000, 0x00000000, 0x00000000, 0x00000000, 0x00000000, 0x00000000, 0x00000000, 0x00000000, 0x00000000, 0x00000000, 0x00000000
.long 0x3f803f80, 0x3f803f80, 0x00000000, 0x00000000, 0x3f803f80, 0x00003f80, 0x00000000, 0x00000000, 0x3f803f80, 0x00000000, 0x00000000, 0x00000000, 0x00003f80, 0x00000000, 0x00000000, 0x00000000
.long 0x00000000, 0x00000000, 0x00000000, 0x00000000, 0x00000000, 0x00000000, 0x00000000, 0x00000000, 0x00000000, 0x00000000, 0x00000000, 0x00000000, 0x00000000, 0x00000000, 0x00000000, 0x00000000
.long 0x00000000, 0x00000000, 0x00000000, 0x00000000, 0x00000000, 0x00000000, 0x00000000, 0x00000000, 0x00000000, 0x00000000, 0x00000000, 0x00000000, 0x00000000, 0x00000000, 0x00000000, 0x00000000
.long 0x00000000, 0x00000000, 0x00000000, 0x00000000, 0x00000000, 0x00000000, 0x00000000, 0x00000000, 0x00000000, 0x00000000, 0x00000000, 0x00000000, 0x00000000, 0x00000000, 0x00000000, 0x00000000
.long 0x00000000, 0x00000000, 0x00000000, 0x00000000, 0x00000000, 0x00000000, 0x00000000, 0x00000000, 0x00000000, 0x00000000, 0x00000000, 0x00000000, 0x00000000, 0x00000000, 0x00000000, 0x00000000
.long 0x00000000, 0x00000000, 0x00000000, 0x00000000, 0x00000000, 0x00000000, 0x00000000, 0x00000000, 0x00000000, 0x00000000, 0x00000000, 0x00000000, 0x00000000, 0x00000000, 0x00000000, 0x00000000
.long 0x00000000, 0x00000000, 0x00000000, 0x00000000, 0x00000000, 0x00000000, 0x00000000, 0x00000000, 0x00000000, 0x00000000, 0x00000000, 0x00000000, 0x00000000, 0x00000000, 0x00000000, 0x00000000
.long 0x00000000, 0x00000000, 0x00000000, 0x00000000, 0x00000000, 0x00000000, 0x00000000, 0x3f800000, 0x00000000, 0x00000000, 0x00000000, 0x3f803f80, 0x00000000, 0x00000000, 0x3f800000, 0x3f803f80
.long 0x00000000, 0x00000000, 0x00000000, 0x00000000, 0x00000000, 0x00000000, 0x00000000, 0x00000000, 0x00000000, 0x00000000, 0x00000000, 0x00000000, 0x00000000, 0x00000000, 0x00000000, 0x00000000
.long 0x00000000, 0x00000000, 0x00000000, 0x00000000, 0x00000000, 0x00000000, 0x00000000, 0x3f800000, 0x00000000, 0x00000000, 0x00000000, 0x3f803f80, 0x00000000, 0x00000000, 0x3f800000, 0x3f803f80
.long 0x00000000, 0x00000000, 0x3f803f80, 0x3f803f80, 0x00000000, 0x3f800000, 0x3f803f80, 0x3f803f80, 0x00000000, 0x3f803f80, 0x3f803f80, 0x3f803f80, 0x3f800000, 0x3f803f80, 0x3f803f80, 0x3f803f80
.long 0x3f803f80, 0x3f803f80, 0x3f803f80, 0x00003f80, 0x3f803f80, 0x3f803f80, 0x3f803f80, 0x00000000, 0x3f803f80, 0x3f803f80, 0x00003f80, 0x00000000, 0x3f803f80, 0x3f803f80, 0x00000000, 0x00000000
.long 0x00000000, 0x00000000, 0x3f803f80, 0x3f803f80, 0x00000000, 0x3f800000, 0x3f803f80, 0x3f803f80, 0x00000000, 0x3f803f80, 0x3f803f80, 0x3f803f80, 0x3f800000, 0x3f803f80, 0x3f803f80, 0x3f803f80
.long 0x3f803f80, 0x3f803f80, 0x3f803f80, 0x00003f80, 0x3f803f80, 0x3f803f80, 0x3f803f80, 0x00000000, 0x3f803f80, 0x3f803f80, 0x00003f80, 0x00000000, 0x3f803f80, 0x3f803f80, 0x00000000, 0x00000000
.long 0x3f803f80, 0x00003f80, 0x00000000, 0x00000000, 0x3f803f80, 0x00000000, 0x00000000, 0x00000000, 0x00003f80, 0x00000000, 0x00000000, 0x00000000, 0x00000000, 0x00000000, 0x00000000, 0x00000000
.long 0x00000000, 0x00000000, 0x00000000, 0x00000000, 0x00000000, 0x00000000, 0x00000000, 0x00000000, 0x00000000, 0x00000000, 0x00000000, 0x00000000, 0x00000000, 0x00000000, 0x00000000, 0x00000000
.long 0x3f803f80, 0x00003f80, 0x00000000, 0x00000000, 0x3f803f80, 0x00000000, 0x00000000, 0x00000000, 0x00003f80, 0x00000000, 0x00000000, 0x00000000, 0x00000000, 0x00000000, 0x00000000, 0x00000000
.long 0x00000000, 0x00000000, 0x00000000, 0x00000000, 0x00000000, 0x00000000, 0x00000000, 0x00000000, 0x00000000, 0x00000000, 0x00000000, 0x00000000, 0x00000000, 0x00000000, 0x00000000, 0x00000000
.long 0x00000000, 0x00000000, 0x00000000, 0x00000000, 0x00000000, 0x00000000, 0x00000000, 0x00000000, 0x00000000, 0x00000000, 0x00000000, 0x00000000, 0x00000000, 0x00000000, 0x00000000, 0x00000000
.long 0x00000000, 0x00000000, 0x00000000, 0x00000000, 0x00000000, 0x00000000, 0x00000000, 0x00000000, 0x00000000, 0x00000000, 0x00000000, 0x00000000, 0x00000000, 0x00000000, 0x00000000, 0x00000000
L_codeend:
.section .rodata,"a"
.p2align 6
.amdhsa_kernel recurrent_scan__ssm_conv_s4d__moe_arch_mod__prompt_kernel
  .amdhsa_next_free_vgpr 256
  .amdhsa_next_free_sgpr 102
  .amdhsa_accum_offset 256
  .amdhsa_group_segment_fixed_size 0
  .amdhsa_kernarg_size 120
  .amdhsa_user_sgpr_count 2
  .amdhsa_user_sgpr_kernarg_segment_ptr 1
  .amdhsa_system_sgpr_workgroup_id_x 1
.end_amdhsa_kernel
```
